```python
import torch

def _softmax(x, axis=-1):
    return torch.softmax(x, dim=axis)
def _gelu(x):
    return torch.nn.functional.gelu(x, approximate="tanh")
def _silu(x):
    return torch.nn.functional.silu(x)
def _sigmoid(x):
    return torch.sigmoid(x)
def _layernorm(x, axis=-1, eps=1e-5):
    m = x.mean(dim=axis, keepdim=True)
    v = x.var(dim=axis, keepdim=True, unbiased=False)
    return (x - m) / torch.sqrt(v + eps)
def _scatter_add(tgt, idx, src, axis=0):
    return tgt.clone().index_add_(axis, idx, src)
def _segment_sum(src, seg, n):
    out = torch.zeros((n,) + src.shape[1:], dtype=src.dtype)
    return out.index_add_(0, seg, src)
def _pad(x, pw):
    flat = tuple(v for pair in reversed(pw) for v in pair)
    return torch.nn.functional.pad(x, flat)

kernel_name = 'sequential_preLN__ssm_conv_h3__glu_gated_geglu__prompt'

def setup_inputs():

    _w = (lambda a: (lambda t: t.to(torch.bfloat16) if t.is_floating_point() else t)(torch.as_tensor(a)))
    def _A_setup():
        B, S, D = 1, 2048, 576
        ks = 4
        return {
            "q": _w((lambda *s: torch.randn(*s, dtype=torch.bfloat16) * 0.05)(B, S, D)),
            "k": _w((lambda *s: torch.randn(*s, dtype=torch.bfloat16) * 0.2)(B, S, D)),
            "v": _w((lambda *s: torch.randn(*s, dtype=torch.bfloat16) * 0.2)(B, S, D)),
            "shift_k": _w((lambda *s: torch.randn(*s, dtype=torch.bfloat16) * 0.2)(D, ks) * 0.5),
            "ssm_k": _w((lambda *s: torch.randn(*s, dtype=torch.bfloat16) * 0.4)(D, S) * (1.0 / S ** 0.5)),
            "ssm_D": _w((lambda *s: torch.randn(*s, dtype=torch.bfloat16) * 0.2)(D)),
        }
    _A_in = _A_setup()

    def _B_setup():
        B, S, Dm, Df = 1, 2048, 576, 4608
        return {
            "x": _w((lambda *s: torch.randn(*s, dtype=torch.bfloat16) * 0.05)(B, S, Dm)),
            "w_gate": _w((lambda *s: torch.randn(*s, dtype=torch.bfloat16) * 0.4)(Dm, Df) * (Dm ** -0.5)),
            "w_up": _w((lambda *s: torch.randn(*s, dtype=torch.bfloat16) * 0.4)(Dm, Df) * (Dm ** -0.5)),
            "w_down": _w((lambda *s: torch.randn(*s, dtype=torch.bfloat16) * 0.4)(Df, Dm) * (Df ** -0.5)),
        }
    _B_in = _B_setup()

    return {
        "A_q": _A_in["q"],
        "A_k": _A_in["k"],
        "A_v": _A_in["v"],
        "A_shift_k": _A_in["shift_k"],
        "A_ssm_k": _A_in["ssm_k"],
        "A_ssm_D": _A_in["ssm_D"],
        "B_x": _B_in["x"],
        "B_w_gate": _B_in["w_gate"],
        "B_w_up": _B_in["w_up"],
        "B_w_down": _B_in["w_down"],
    }

def reference(A_q, A_k, A_v, A_shift_k, A_ssm_k, A_ssm_D, B_x, B_w_gate, B_w_up, B_w_down):
    def _A_ref(q, k, v, shift_k, ssm_k, ssm_D):
        B, S, D = q.shape
        ks = shift_k.shape[-1]
        k_pad = _pad(k, ((0, 0), (ks - 1, 0), (0, 0)))
        k_shift = torch.zeros_like(k)
        for t in range(ks):
            k_shift = k_shift + k_pad[:, t:t + S, :] * shift_k[:, ks - 1 - t][None, None, :]
        kv = k_shift * v
        L = 2 * S
        kv_pad = _pad(kv, ((0, 0), (0, S), (0, 0)))
        kf_pad = _pad(ssm_k, ((0, 0), (0, S)))
        kv_f = (lambda x, axes=(-2,-1): torch.fft.rfft2(x.float(), dim=axes))(kv_pad[:, None, :, :], axes=(1, 2))
        kf_f = (lambda x, axes=(-2,-1): torch.fft.rfft2(x.float(), dim=axes))(kf_pad[:, None, :], axes=(1, 2))
        kf_f = (lambda x, *d: x.permute(*d))(kf_f, 1, 2, 0)
        y_f = kv_f * kf_f[None, :, :, :]
        y = (lambda x, s, axes=(-2,-1): torch.fft.irfft2(x, s=s, dim=axes).to(torch.bfloat16))(y_f, (1, L), axes=(1, 2))[:, 0, :S, :]
        y = y + kv * ssm_D[None, None, :]
        return q * y

    def _B_ref(x, w_gate, w_up, w_down):
        g = torch.einsum("bsd,df->bsf", x, w_gate)
        u = torch.einsum("bsd,df->bsf", x, w_up)
        h = _gelu(g) * u
        return torch.einsum("bsf,fd->bsd", h, w_down)

    x = A_q
    h = x + _A_ref(_layernorm(x, axis=-1), A_k, A_v, A_shift_k, A_ssm_k, A_ssm_D)
    h2 = h + _B_ref(_layernorm(h, axis=-1), B_w_gate, B_w_up, B_w_down)
    return h2
```

```asm
; @launch grid=(256,1,1) block=(512,1,1) lds=161024
.amdgcn_target "amdgcn-amd-amdhsa--gfx950"
.text
.globl sequential_preLN__ssm_conv_h3__glu_gated_geglu__prompt_kernel
.p2align 8
.type sequential_preLN__ssm_conv_h3__glu_gated_geglu__prompt_kernel,@function
sequential_preLN__ssm_conv_h3__glu_gated_geglu__prompt_kernel:
    s_cmp_ge_u32 s2, 256
    s_cbranch_scc1 KB_done
    s_load_dwordx4 s[4:7], s[0:1], 8
    s_load_dwordx4 s[8:11], s[0:1], 24
    s_load_dwordx2 s[44:45], s[0:1], 40
    s_load_dwordx4 s[48:51], s[0:1], 88
    s_load_dwordx2 s[46:47], s[0:1], 0
    v_lshrrev_b32 v1, 6, v0
    v_and_b32 v9, 63, v0
    v_readfirstlane_b32 s3, v1
    s_and_b32 s12, s2, 7
    s_lshr_b32 s13, s2, 3
    v_lshlrev_b32 v1, 4, v9
    v_mov_b32 v2, 0
    s_mul_i32 s14, s13, 9
    s_add_u32 s15, s14, 9
    s_lshr_b32 s14, s14, 2
    s_lshr_b32 s15, s15, 2
    s_mul_i32 s16, s12, 72
    s_add_u32 s41, s14, s16
    s_add_u32 s42, s15, s16
    s_add_u32 s14, s41, s3
    s_cmp_ge_u32 s14, s42
    s_cbranch_scc1 M_idle
    s_lshr_b32 s40, s14, 5
    s_and_b32 s15, s14, 31
    v_and_b32 v10, 7, v9
    v_lshrrev_b32 v11, 3, v9
    s_lshl_b32 s16, s40, 5
    v_lshl_add_u32 v3, v10, 2, s16
    s_lshl_b32 s15, s15, 6
    v_lshl_add_u32 v4, v11, 3, s15
    s_movk_i32 s16, 1152
    v_mul_u32_u24 v5, s16, v4
    v_lshl_add_u32 v5, v3, 1, v5
    v_add_u32 v6, 4608, v5
    v_subrev_u32 v7, 3456, v5
    v_cmp_eq_u32 vcc, 0, v4
    v_mov_b32 v8, 0x80000000
    s_nop 0
    v_cndmask_b32 v7, v7, v8, vcc
    v_lshlrev_b32 v8, 3, v3
    s_waitcnt lgkmcnt(0)
    s_add_u32 s52, s50, 66060288
    s_addc_u32 s53, s51, 0
    s_mov_b32 s54, 44288
    s_mov_b32 s55, 0x00020000
    s_or_b32 s17, s2, s3
    s_cbranch_scc1 M_i1
    v_lshlrev_b32 v12, 7, v9
    s_mov_b32 s16, 40960
    buffer_store_dword v2, v12, s[52:55], s16 offen sc0 sc1
M_i1:
    s_mov_b32 s20, s4
    s_mov_b32 s21, s5
    s_mov_b32 s22, 2359296
    s_mov_b32 s23, 0x00020000
    s_mov_b32 s24, s6
    s_mov_b32 s25, s7
    s_mov_b32 s26, 2359296
    s_mov_b32 s27, 0x00020000
    s_mov_b32 s28, s8
    s_mov_b32 s29, s9
    s_mov_b32 s30, 4608
    s_mov_b32 s31, 0x00020000
    buffer_load_dwordx4 v[56:59], v8, s[28:31], 0 offen
    buffer_load_dwordx4 v[60:63], v8, s[28:31], 0 offen offset:16
    buffer_load_dwordx2 v[16:17], v7, s[20:23], 0 offen offset:0
    buffer_load_dwordx2 v[18:19], v7, s[20:23], 0 offen offset:1152
    buffer_load_dwordx2 v[20:21], v7, s[20:23], 0 offen offset:2304
    buffer_load_dwordx2 v[22:23], v5, s[20:23], 0 offen offset:0
    buffer_load_dwordx2 v[24:25], v5, s[20:23], 0 offen offset:1152
    buffer_load_dwordx2 v[26:27], v5, s[20:23], 0 offen offset:2304
    buffer_load_dwordx2 v[28:29], v5, s[20:23], 0 offen offset:3456
    buffer_load_dwordx2 v[30:31], v6, s[20:23], 0 offen offset:0
    buffer_load_dwordx2 v[32:33], v6, s[20:23], 0 offen offset:1152
    buffer_load_dwordx2 v[34:35], v6, s[20:23], 0 offen offset:2304
    buffer_load_dwordx2 v[36:37], v6, s[20:23], 0 offen offset:3456
    buffer_load_dwordx2 v[40:41], v5, s[24:27], 0 offen offset:0
    buffer_load_dwordx2 v[42:43], v5, s[24:27], 0 offen offset:1152
    buffer_load_dwordx2 v[44:45], v5, s[24:27], 0 offen offset:2304
    buffer_load_dwordx2 v[46:47], v5, s[24:27], 0 offen offset:3456
    buffer_load_dwordx2 v[48:49], v6, s[24:27], 0 offen offset:0
    buffer_load_dwordx2 v[50:51], v6, s[24:27], 0 offen offset:1152
    buffer_load_dwordx2 v[52:53], v6, s[24:27], 0 offen offset:2304
    buffer_load_dwordx2 v[54:55], v6, s[24:27], 0 offen offset:3456
    s_mov_b32 s32, s50
    s_mov_b32 s33, s51
    s_mov_b32 s34, 2359296
    s_mov_b32 s35, 0x00020000
    s_mov_b32 s36, s48
    s_mov_b32 s37, s49
    s_mov_b32 s38, 256
    s_mov_b32 s39, 0x00020000
    s_or_b32 s17, s2, s3
    s_cbranch_scc1 M_i2
    s_waitcnt vmcnt(21)
    v_mov_b32 v12, 1
    s_mov_b64 exec, 1
    buffer_store_dword v12, v2, s[36:39], 0 offen sc0 sc1
    s_mov_b64 exec, -1
M_i2:
    v_lshlrev_b32 v10, 12, v3
    v_lshlrev_b32 v11, 1, v4
    v_sub_u32 v10, v10, v11
    v_add_u32 v10, 4080, v10
    v_add_u32 v11, 8192, v10
    s_mov_b32 s18, 0xffff0000
    s_waitcnt vmcnt(19)
    v_lshlrev_b32 v64, 16, v56
    v_and_b32 v66, s18, v56
    v_lshlrev_b32 v68, 16, v57
    v_and_b32 v70, s18, v57
    v_lshlrev_b32 v65, 16, v58
    v_and_b32 v67, s18, v58
    v_lshlrev_b32 v69, 16, v59
    v_and_b32 v71, s18, v59
    v_lshlrev_b32 v72, 16, v60
    v_and_b32 v74, s18, v60
    v_lshlrev_b32 v76, 16, v61
    v_and_b32 v78, s18, v61
    v_lshlrev_b32 v73, 16, v62
    v_and_b32 v75, s18, v62
    v_lshlrev_b32 v77, 16, v63
    v_and_b32 v79, s18, v63
    s_waitcnt vmcnt(8)
    v_lshlrev_b32 v80, 16, v16
    v_and_b32 v81, s18, v16
    v_lshlrev_b32 v82, 16, v17
    v_and_b32 v83, s18, v17
    v_lshlrev_b32 v84, 16, v18
    v_and_b32 v85, s18, v18
    v_lshlrev_b32 v86, 16, v19
    v_and_b32 v87, s18, v19
    v_lshlrev_b32 v88, 16, v20
    v_and_b32 v89, s18, v20
    v_lshlrev_b32 v90, 16, v21
    v_and_b32 v91, s18, v21
    v_lshlrev_b32 v92, 16, v22
    v_and_b32 v93, s18, v22
    v_lshlrev_b32 v94, 16, v23
    v_and_b32 v95, s18, v23
    v_lshlrev_b32 v96, 16, v24
    v_and_b32 v97, s18, v24
    v_lshlrev_b32 v98, 16, v25
    v_and_b32 v99, s18, v25
    v_lshlrev_b32 v100, 16, v26
    v_and_b32 v101, s18, v26
    v_lshlrev_b32 v102, 16, v27
    v_and_b32 v103, s18, v27
    v_lshlrev_b32 v104, 16, v28
    v_and_b32 v105, s18, v28
    v_lshlrev_b32 v106, 16, v29
    v_and_b32 v107, s18, v29
    v_lshlrev_b32 v108, 16, v30
    v_and_b32 v109, s18, v30
    v_lshlrev_b32 v110, 16, v31
    v_and_b32 v111, s18, v31
    v_lshlrev_b32 v112, 16, v32
    v_and_b32 v113, s18, v32
    v_lshlrev_b32 v114, 16, v33
    v_and_b32 v115, s18, v33
    v_lshlrev_b32 v116, 16, v34
    v_and_b32 v117, s18, v34
    v_lshlrev_b32 v118, 16, v35
    v_and_b32 v119, s18, v35
    v_lshlrev_b32 v120, 16, v36
    v_and_b32 v121, s18, v36
    v_lshlrev_b32 v122, 16, v37
    v_and_b32 v123, s18, v37
    v_pk_mul_f32 v[124:125], v[80:81], v[70:71]
    v_pk_fma_f32 v[124:125], v[84:85], v[68:69], v[124:125]
    v_pk_fma_f32 v[124:125], v[88:89], v[66:67], v[124:125]
    v_pk_fma_f32 v[124:125], v[92:93], v[64:65], v[124:125]
    v_pk_mul_f32 v[126:127], v[82:83], v[78:79]
    v_pk_fma_f32 v[126:127], v[86:87], v[76:77], v[126:127]
    v_pk_fma_f32 v[126:127], v[90:91], v[74:75], v[126:127]
    v_pk_fma_f32 v[126:127], v[94:95], v[72:73], v[126:127]
    v_pk_mul_f32 v[128:129], v[84:85], v[70:71]
    v_pk_fma_f32 v[128:129], v[88:89], v[68:69], v[128:129]
    v_pk_fma_f32 v[128:129], v[92:93], v[66:67], v[128:129]
    v_pk_fma_f32 v[128:129], v[96:97], v[64:65], v[128:129]
    v_pk_mul_f32 v[130:131], v[86:87], v[78:79]
    v_pk_fma_f32 v[130:131], v[90:91], v[76:77], v[130:131]
    v_pk_fma_f32 v[130:131], v[94:95], v[74:75], v[130:131]
    v_pk_fma_f32 v[130:131], v[98:99], v[72:73], v[130:131]
    v_pk_mul_f32 v[132:133], v[88:89], v[70:71]
    v_pk_fma_f32 v[132:133], v[92:93], v[68:69], v[132:133]
    v_pk_fma_f32 v[132:133], v[96:97], v[66:67], v[132:133]
    v_pk_fma_f32 v[132:133], v[100:101], v[64:65], v[132:133]
    v_pk_mul_f32 v[134:135], v[90:91], v[78:79]
    v_pk_fma_f32 v[134:135], v[94:95], v[76:77], v[134:135]
    v_pk_fma_f32 v[134:135], v[98:99], v[74:75], v[134:135]
    v_pk_fma_f32 v[134:135], v[102:103], v[72:73], v[134:135]
    v_pk_mul_f32 v[136:137], v[92:93], v[70:71]
    v_pk_fma_f32 v[136:137], v[96:97], v[68:69], v[136:137]
    v_pk_fma_f32 v[136:137], v[100:101], v[66:67], v[136:137]
    v_pk_fma_f32 v[136:137], v[104:105], v[64:65], v[136:137]
    v_pk_mul_f32 v[138:139], v[94:95], v[78:79]
    v_pk_fma_f32 v[138:139], v[98:99], v[76:77], v[138:139]
    v_pk_fma_f32 v[138:139], v[102:103], v[74:75], v[138:139]
    v_pk_fma_f32 v[138:139], v[106:107], v[72:73], v[138:139]
    v_pk_mul_f32 v[140:141], v[96:97], v[70:71]
    v_pk_fma_f32 v[140:141], v[100:101], v[68:69], v[140:141]
    v_pk_fma_f32 v[140:141], v[104:105], v[66:67], v[140:141]
    v_pk_fma_f32 v[140:141], v[108:109], v[64:65], v[140:141]
    v_pk_mul_f32 v[142:143], v[98:99], v[78:79]
    v_pk_fma_f32 v[142:143], v[102:103], v[76:77], v[142:143]
    v_pk_fma_f32 v[142:143], v[106:107], v[74:75], v[142:143]
    v_pk_fma_f32 v[142:143], v[110:111], v[72:73], v[142:143]
    v_pk_mul_f32 v[144:145], v[100:101], v[70:71]
    v_pk_fma_f32 v[144:145], v[104:105], v[68:69], v[144:145]
    v_pk_fma_f32 v[144:145], v[108:109], v[66:67], v[144:145]
    v_pk_fma_f32 v[144:145], v[112:113], v[64:65], v[144:145]
    v_pk_mul_f32 v[146:147], v[102:103], v[78:79]
    v_pk_fma_f32 v[146:147], v[106:107], v[76:77], v[146:147]
    v_pk_fma_f32 v[146:147], v[110:111], v[74:75], v[146:147]
    v_pk_fma_f32 v[146:147], v[114:115], v[72:73], v[146:147]
    v_pk_mul_f32 v[148:149], v[104:105], v[70:71]
    v_pk_fma_f32 v[148:149], v[108:109], v[68:69], v[148:149]
    v_pk_fma_f32 v[148:149], v[112:113], v[66:67], v[148:149]
    v_pk_fma_f32 v[148:149], v[116:117], v[64:65], v[148:149]
    v_pk_mul_f32 v[150:151], v[106:107], v[78:79]
    v_pk_fma_f32 v[150:151], v[110:111], v[76:77], v[150:151]
    v_pk_fma_f32 v[150:151], v[114:115], v[74:75], v[150:151]
    v_pk_fma_f32 v[150:151], v[118:119], v[72:73], v[150:151]
    v_pk_mul_f32 v[152:153], v[108:109], v[70:71]
    v_pk_fma_f32 v[152:153], v[112:113], v[68:69], v[152:153]
    v_pk_fma_f32 v[152:153], v[116:117], v[66:67], v[152:153]
    v_pk_fma_f32 v[152:153], v[120:121], v[64:65], v[152:153]
    v_pk_mul_f32 v[154:155], v[110:111], v[78:79]
    v_pk_fma_f32 v[154:155], v[114:115], v[76:77], v[154:155]
    v_pk_fma_f32 v[154:155], v[118:119], v[74:75], v[154:155]
    v_pk_fma_f32 v[154:155], v[122:123], v[72:73], v[154:155]
    s_waitcnt vmcnt(0)
    v_lshlrev_b32 v16, 16, v40
    v_and_b32 v17, s18, v40
    v_pk_mul_f32 v[124:125], v[124:125], v[16:17]
    v_lshlrev_b32 v18, 16, v41
    v_and_b32 v19, s18, v41
    v_pk_mul_f32 v[126:127], v[126:127], v[18:19]
    v_lshlrev_b32 v20, 16, v42
    v_and_b32 v21, s18, v42
    v_pk_mul_f32 v[128:129], v[128:129], v[20:21]
    v_lshlrev_b32 v22, 16, v43
    v_and_b32 v23, s18, v43
    v_pk_mul_f32 v[130:131], v[130:131], v[22:23]
    v_lshlrev_b32 v24, 16, v44
    v_and_b32 v25, s18, v44
    v_pk_mul_f32 v[132:133], v[132:133], v[24:25]
    v_lshlrev_b32 v26, 16, v45
    v_and_b32 v27, s18, v45
    v_pk_mul_f32 v[134:135], v[134:135], v[26:27]
    v_lshlrev_b32 v28, 16, v46
    v_and_b32 v29, s18, v46
    v_pk_mul_f32 v[136:137], v[136:137], v[28:29]
    v_lshlrev_b32 v30, 16, v47
    v_and_b32 v31, s18, v47
    v_pk_mul_f32 v[138:139], v[138:139], v[30:31]
    v_lshlrev_b32 v16, 16, v48
    v_and_b32 v17, s18, v48
    v_pk_mul_f32 v[140:141], v[140:141], v[16:17]
    v_lshlrev_b32 v18, 16, v49
    v_and_b32 v19, s18, v49
    v_pk_mul_f32 v[142:143], v[142:143], v[18:19]
    v_lshlrev_b32 v20, 16, v50
    v_and_b32 v21, s18, v50
    v_pk_mul_f32 v[144:145], v[144:145], v[20:21]
    v_lshlrev_b32 v22, 16, v51
    v_and_b32 v23, s18, v51
    v_pk_mul_f32 v[146:147], v[146:147], v[22:23]
    v_lshlrev_b32 v24, 16, v52
    v_and_b32 v25, s18, v52
    v_pk_mul_f32 v[148:149], v[148:149], v[24:25]
    v_lshlrev_b32 v26, 16, v53
    v_and_b32 v27, s18, v53
    v_pk_mul_f32 v[150:151], v[150:151], v[26:27]
    v_lshlrev_b32 v28, 16, v54
    v_and_b32 v29, s18, v54
    v_pk_mul_f32 v[152:153], v[152:153], v[28:29]
    v_lshlrev_b32 v30, 16, v55
    v_and_b32 v31, s18, v55
    v_pk_mul_f32 v[154:155], v[154:155], v[30:31]
    v_cvt_pk_bf16_f32 v80, v152, v148
    v_cvt_pk_bf16_f32 v81, v144, v140
    v_cvt_pk_bf16_f32 v82, v136, v132
    v_cvt_pk_bf16_f32 v83, v128, v124
    buffer_store_dwordx4 v[80:83], v10, s[32:35], 0 offen sc1
    v_cvt_pk_bf16_f32 v84, v153, v149
    v_cvt_pk_bf16_f32 v85, v145, v141
    v_cvt_pk_bf16_f32 v86, v137, v133
    v_cvt_pk_bf16_f32 v87, v129, v125
    v_add_u32 v10, 4096, v10
    buffer_store_dwordx4 v[84:87], v10, s[32:35], 0 offen sc1
    v_cvt_pk_bf16_f32 v88, v154, v150
    v_cvt_pk_bf16_f32 v89, v146, v142
    v_cvt_pk_bf16_f32 v90, v138, v134
    v_cvt_pk_bf16_f32 v91, v130, v126
    buffer_store_dwordx4 v[88:91], v11, s[32:35], 0 offen sc1
    v_cvt_pk_bf16_f32 v92, v155, v151
    v_cvt_pk_bf16_f32 v93, v147, v143
    v_cvt_pk_bf16_f32 v94, v139, v135
    v_cvt_pk_bf16_f32 v95, v131, v127
    v_add_u32 v11, 4096, v11
    buffer_store_dwordx4 v[92:95], v11, s[32:35], 0 offen sc1
    s_waitcnt vmcnt(0)
    s_branch M_fill
M_idle:
    s_waitcnt lgkmcnt(0)
    s_mov_b32 s36, s48
    s_mov_b32 s37, s49
    s_mov_b32 s38, 256
    s_mov_b32 s39, 0x00020000
    s_add_u32 s52, s50, 66060288
    s_addc_u32 s53, s51, 0
    s_mov_b32 s54, 44288
    s_mov_b32 s55, 0x00020000
M_f1:
    s_cmp_lg_u32 s3, 7
    s_cbranch_scc1 M_f1b
    s_lshr_b32 s17, s13, 2
    s_lshl_b32 s17, s17, 5
    s_lshl_b32 s19, s12, 2
    s_add_u32 s17, s17, s19
    s_and_b32 s19, s13, 3
    s_add_u32 s17, s17, s19
    s_mul_i32 s17, s17, 9216
    s_mov_b32 s20, s46
    s_mov_b32 s21, s47
    s_mov_b32 s22, 2359296
    s_mov_b32 s23, 0x00020000
    v_lshlrev_b32 v12, 7, v9
    buffer_load_dword v255, v12, s[20:23], s17 offen
    s_add_u32 s17, s17, 8192
    s_mov_b64 exec, 0xff
    buffer_load_dword v254, v12, s[20:23], s17 offen
    s_mov_b64 exec, -1
    buffer_load_dword v12, v2, s[36:39], 0 offen sc1
    s_waitcnt vmcnt(0)
    s_mov_b32 s58, 0
M_rwa:
    v_readfirstlane_b32 s59, v12
    s_add_u32 s58, s58, 1
    s_cmp_ge_u32 s59, 1
    s_cbranch_scc1 M_rga
    s_cmp_lt_u32 s58, 0x40000
    s_cbranch_scc0 M_rga
    s_sleep 8
    buffer_load_dword v12, v2, s[36:39], 0 offen offset:0 sc1
    s_waitcnt vmcnt(0)
    s_branch M_rwa
M_rga:
M_f1b:
    s_cmp_ge_u32 s13, 18
    s_cbranch_scc1 M_f1e
    s_sub_u32 s16, s3, 3
    s_cmp_ge_u32 s16, 4
    s_cbranch_scc1 M_fill
    s_mul_i32 s17, s12, 18
    s_add_u32 s17, s17, s13
    s_lshl_b32 s17, s17, 2
    s_add_u32 s43, s16, s17
    s_lshl_b32 s43, s43, 12
    s_mul_i32 s40, s16, 22528
    s_add_u32 s40, s40, 40960
    s_mov_b32 s20, s10
    s_mov_b32 s21, s11
    s_mov_b32 s22, 2359296
    s_mov_b32 s23, 0x00020000
    buffer_load_dwordx4 v[160:163], v1, s[20:23], s43 offen offset:0
    buffer_load_dwordx2 v[164:165], v1, s[20:23], s43 offen offset:16
    buffer_load_dwordx4 v[166:169], v1, s[20:23], s43 offen offset:1024
    buffer_load_dwordx2 v[170:171], v1, s[20:23], s43 offen offset:1040
    buffer_load_dwordx4 v[172:175], v1, s[20:23], s43 offen offset:2048
    buffer_load_dwordx2 v[176:177], v1, s[20:23], s43 offen offset:2064
    buffer_load_dwordx4 v[178:181], v1, s[20:23], s43 offen offset:3072
    buffer_load_dwordx2 v[182:183], v1, s[20:23], s43 offen offset:3088
    buffer_load_dwordx2 v[156:157], v2, s[20:23], s43 offen
    v_mov_b32 v12, 0
    v_mov_b32 v13, 0
    v_mov_b32 v14, 0
    v_mov_b32 v15, 0
    v_mul_u32_u24 v7, 5462, v9
    v_lshrrev_b32 v7, 16, v7
    v_mul_u32_u24 v8, 12, v7
    v_sub_u32 v8, v9, v8
    s_movk_i32 s19, 4416
    v_mul_u32_u24 v7, s19, v7
    v_lshlrev_b32 v10, 4, v8
    v_add_u32 v11, 4096, v10
    v_cmp_gt_u32 vcc, 4, v8
    s_nop 1
    v_cndmask_b32 v10, v11, v10, vcc
    v_add3_u32 v7, v7, v10, s40
    v_add_u32 v10, 21760, v1
    v_cmp_eq_u32 vcc, 0, v9
    v_mov_b32 v11, 17664
    s_nop 0
    v_cndmask_b32 v10, v10, v11, vcc
    v_add_u32 v10, s40, v10
    s_mov_b32 exec_hi, 0xffff
    ds_write_b128 v7, v[12:15]
    s_mov_b32 exec_hi, 0x1ff
    ds_write_b128 v10, v[12:15]
    s_mov_b64 exec, -1
    v_add_u32 v22, s40, v1
    v_sub_u32 v19, 3, v9
    v_lshlrev_b32 v19, 4, v19
    v_mul_u32_u24 v20, s19, v9
    v_add_u32 v20, s40, v20
    s_waitcnt vmcnt(0)
    v_alignbyte_b32 v184, v161, v160, 2
    v_alignbyte_b32 v185, v162, v161, 2
    v_alignbyte_b32 v186, v163, v162, 2
    v_alignbyte_b32 v187, v164, v163, 2
    ds_write_b128 v22, v[184:187] offset:64
    v_mov_b32 v188, v161
    v_mov_b32 v189, v162
    v_mov_b32 v190, v163
    v_mov_b32 v191, v164
    ds_write_b128 v22, v[188:191] offset:4480
    v_alignbyte_b32 v192, v162, v161, 2
    v_alignbyte_b32 v193, v163, v162, 2
    v_alignbyte_b32 v194, v164, v163, 2
    v_alignbyte_b32 v195, v165, v164, 2
    ds_write_b128 v22, v[192:195] offset:8896
    ds_write_b128 v22, v[162:165] offset:13312
    v_alignbyte_b32 v184, v167, v166, 2
    v_alignbyte_b32 v185, v168, v167, 2
    v_alignbyte_b32 v186, v169, v168, 2
    v_alignbyte_b32 v187, v170, v169, 2
    ds_write_b128 v22, v[184:187] offset:1088
    v_mov_b32 v188, v167
    v_mov_b32 v189, v168
    v_mov_b32 v190, v169
    v_mov_b32 v191, v170
    ds_write_b128 v22, v[188:191] offset:5504
    v_alignbyte_b32 v192, v168, v167, 2
    v_alignbyte_b32 v193, v169, v168, 2
    v_alignbyte_b32 v194, v170, v169, 2
    v_alignbyte_b32 v195, v171, v170, 2
    ds_write_b128 v22, v[192:195] offset:9920
    ds_write_b128 v22, v[168:171] offset:14336
    v_alignbyte_b32 v184, v173, v172, 2
    v_alignbyte_b32 v185, v174, v173, 2
    v_alignbyte_b32 v186, v175, v174, 2
    v_alignbyte_b32 v187, v176, v175, 2
    ds_write_b128 v22, v[184:187] offset:2112
    v_mov_b32 v188, v173
    v_mov_b32 v189, v174
    v_mov_b32 v190, v175
    v_mov_b32 v191, v176
    ds_write_b128 v22, v[188:191] offset:6528
    v_alignbyte_b32 v192, v174, v173, 2
    v_alignbyte_b32 v193, v175, v174, 2
    v_alignbyte_b32 v194, v176, v175, 2
    v_alignbyte_b32 v195, v177, v176, 2
    ds_write_b128 v22, v[192:195] offset:10944
    ds_write_b128 v22, v[174:177] offset:15360
    v_alignbyte_b32 v184, v179, v178, 2
    v_alignbyte_b32 v185, v180, v179, 2
    v_alignbyte_b32 v186, v181, v180, 2
    v_alignbyte_b32 v187, v182, v181, 2
    ds_write_b128 v22, v[184:187] offset:3136
    v_mov_b32 v188, v179
    v_mov_b32 v189, v180
    v_mov_b32 v190, v181
    v_mov_b32 v191, v182
    ds_write_b128 v22, v[188:191] offset:7552
    v_alignbyte_b32 v192, v180, v179, 2
    v_alignbyte_b32 v193, v181, v180, 2
    v_alignbyte_b32 v194, v182, v181, 2
    v_alignbyte_b32 v195, v183, v182, 2
    ds_write_b128 v22, v[192:195] offset:11968
    ds_write_b128 v22, v[180:183] offset:16384
    v_lshlrev_b64 v[156:157], v19, v[156:157]
    s_mov_b64 exec, 0xf
    ds_write_b64 v20, v[156:157] offset:56
    s_mov_b64 exec, -1
    s_branch M_fill
M_f1e:
    s_sub_u32 s16, s3, 3
    s_cmp_ge_u32 s16, 4
    s_cbranch_scc1 M_f1g
    s_sub_u32 s17, s13, 18
    s_mul_i32 s14, s12, 14
    s_add_u32 s14, s14, s17
    s_lshl_b32 s14, s14, 2
    s_add_u32 s14, s14, s16
    v_mov_b32 v4, 0
    v_mov_b32 v5, 0
    v_mov_b32 v6, 0
    v_mov_b32 v7, 0
    v_mov_b32 v12, -1
    v_mov_b32 v13, -1
    v_mov_b32 v14, -1
    v_mov_b32 v15, -1
    s_add_u32 s20, s50, 4194304
    s_addc_u32 s21, s51, 0
    s_mov_b32 s22, 2359296
    s_mov_b32 s23, 0x00020000
    s_add_u32 s24, s50, 12582912
    s_addc_u32 s25, s51, 0
    s_mov_b32 s26, 2359296
    s_mov_b32 s27, 0x00020000
    s_cmp_ge_u32 s14, 40
    s_cbranch_scc1 M_f2
    s_lshl_b32 s16, s14, 10
    buffer_store_dwordx4 v[4:7], v1, s[52:55], s16 offen sc1
M_f2:
    s_mul_i32 s16, s14, 6144
    s_add_u32 s17, s16, 4096
    buffer_store_dwordx4 v[12:15], v1, s[20:23], s16 offen offset:0 sc1
    buffer_store_dwordx4 v[12:15], v1, s[24:27], s16 offen offset:0 sc1
    buffer_store_dwordx4 v[12:15], v1, s[20:23], s16 offen offset:1024 sc1
    buffer_store_dwordx4 v[12:15], v1, s[24:27], s16 offen offset:1024 sc1
    buffer_store_dwordx4 v[12:15], v1, s[20:23], s16 offen offset:2048 sc1
    buffer_store_dwordx4 v[12:15], v1, s[24:27], s16 offen offset:2048 sc1
    buffer_store_dwordx4 v[12:15], v1, s[20:23], s16 offen offset:3072 sc1
    buffer_store_dwordx4 v[12:15], v1, s[24:27], s16 offen offset:3072 sc1
    buffer_store_dwordx4 v[12:15], v1, s[20:23], s17 offen offset:0 sc1
    buffer_store_dwordx4 v[12:15], v1, s[24:27], s17 offen offset:0 sc1
    buffer_store_dwordx4 v[12:15], v1, s[20:23], s17 offen offset:1024 sc1
    buffer_store_dwordx4 v[12:15], v1, s[24:27], s17 offen offset:1024 sc1
    s_waitcnt vmcnt(0)
    s_branch M_fill
M_f1g:
    s_sub_u32 s17, s13, 26
    s_cmp_ge_u32 s17, 6
    s_cbranch_scc1 M_fill
    s_cmp_lt_u32 s3, 7
    s_cbranch_scc1 M_fill
    s_getpc_b64 s[28:29]
M_pc:
    s_sub_u32 s28, s28, M_pc-sequential_preLN__ssm_conv_h3__glu_gated_geglu__prompt_kernel
    s_subb_u32 s29, s29, 0
    s_mov_b32 s30, TEXT_END-sequential_preLN__ssm_conv_h3__glu_gated_geglu__prompt_kernel
    s_mov_b32 s31, 0x00020000
    s_lshl_b32 s16, s17, 13
    v_lshlrev_b32 v3, 7, v9
    buffer_load_dword v255, v3, s[28:31], s16 offen
M_fill:
    s_barrier
    s_cmp_lg_u32 s3, 7
    s_cbranch_scc1 M_f1c
    s_lshr_b32 s14, s41, 5
    s_add_u32 s15, s14, 1
    s_lshl_b32 s15, s15, 5
    s_min_u32 s15, s15, s42
    s_sub_u32 s16, s15, s41
    s_sub_u32 s17, s42, s15
    s_lshl_b32 s14, s14, 7
    s_add_u32 s14, s14, 40960
    v_mov_b32 v12, s16
    v_mov_b32 v13, s17
    s_mov_b64 exec, 1
    buffer_atomic_add v12, v2, s[52:55], s14 offen sc1
    s_cmp_eq_u32 s17, 0
    s_cbranch_scc1 M_f1d
    buffer_atomic_add v13, v2, s[52:55], s14 offen offset:128 sc1
M_f1d:
    s_mov_b64 exec, -1
    s_nop 1
M_f1c:
    s_waitcnt lgkmcnt(0)
    s_load_dwordx2 s[8:9], s[0:1], 0
    s_load_dwordx2 s[10:11], s[0:1], 96
    s_load_dwordx4 s[4:7], s[0:1], 56
    s_load_dwordx4 s[44:47], s[0:1], 72
    v_lshrrev_b32 v1, 6, v0
    v_and_b32 v0, 63, v0
    v_readfirstlane_b32 s3, v1
    s_and_b32 s12, s2, 7
    s_lshr_b32 s13, s2, 3
    s_lshl_b32 s12, s12, 2
    s_and_b32 s14, s13, 3
    s_add_u32 s12, s12, s14
    s_lshr_b32 s43, s13, 2
    s_lshl_b32 s13, s43, 3
    s_add_u32 s13, s13, s3
    s_lshl_b32 s39, s43, 5
    s_add_u32 s39, s39, s12
    v_and_b32 v212, 7, v0
    v_lshrrev_b32 v213, 3, v0
    s_lshl_b32 s17, s39, 3
    v_add_u32 v214, s17, v212
    s_movk_i32 s18, 1152
    v_mul_u32_u24 v214, s18, v214
    s_lshl_b32 s17, s3, 4
    s_add_u32 s17, s17, 1024
    v_add_u32 v215, s17, v214
    v_lshl_add_u32 v215, v213, 1, v215
    v_lshl_add_u32 v214, v213, 4, v214
    s_lshl_b32 s17, s3, 7
    v_add_u32 v214, s17, v214
    v_lshlrev_b32 v8, 4, v0
    s_mul_i32 s36, s39, 9216
    s_lshl_b32 s17, s3, 10
    s_add_u32 s37, s36, s17
    s_add_u32 s38, s17, 149504
    s_lshl_b32 s17, s3, 7
    s_add_u32 s36, s36, s17
    s_add_u32 s36, s36, 8192
    v_lshlrev_b32 v216, 1, v0
    s_waitcnt lgkmcnt(0)
    s_mov_b32 s20, s8
    s_mov_b32 s21, s9
    s_mov_b32 s22, 2359296
    s_mov_b32 s23, 0x00020000
    s_add_u32 s28, s10, 4194304
    s_addc_u32 s29, s11, 0
    s_mov_b32 s30, 2359296
    s_mov_b32 s31, 0x00020000
    buffer_load_dwordx4 v[224:227], v214, s[20:23], 0 offen
    buffer_load_ushort v228, v215, s[20:23], 0 offen
    s_mov_b32 s82, s37
    s_mov_b32 s83, s36
    s_and_b32 s14, s3, 3
    s_mul_i32 s15, s14, 5
    s_cmp_eq_u32 s14, 3
    s_cselect_b32 s15, 14, s15
    s_lshl_b32 s17, s15, 6
    s_movk_i32 s18, 9216
    s_sub_u32 s57, 0, s12
    s_and_b32 s57, s57, 3
    s_add_u32 s57, s57, 4
    s_lshl_b32 s56, s57, 1
    s_mov_b32 s95, s57
    v_add_u32 v11, s17, v0
    v_mul_u32_u24 v12, 3641, v11
    v_lshrrev_b32 v12, 16, v12
    v_mul_u32_u24 v13, 18, v12
    v_sub_u32 v13, v11, v13
    v_add_u32 v13, s56, v13
    v_subrev_u32 v11, 18, v13
    v_min_u32 v13, v13, v11
    v_mul_u32_u24 v12, s18, v12
    v_lshl_add_u32 v1, v13, 4, v12
    v_add_u32 v11, s17, v0
    v_add_u32 v11, 64, v11
    v_mul_u32_u24 v12, 3641, v11
    v_lshrrev_b32 v12, 16, v12
    v_mul_u32_u24 v13, 18, v12
    v_sub_u32 v13, v11, v13
    v_add_u32 v13, s56, v13
    v_subrev_u32 v11, 18, v13
    v_min_u32 v13, v13, v11
    v_mul_u32_u24 v12, s18, v12
    v_lshl_add_u32 v2, v13, 4, v12
    v_subrev_u32 v2, 1024, v2
    v_add_u32 v11, s17, v0
    v_add_u32 v11, 128, v11
    v_mul_u32_u24 v12, 3641, v11
    v_lshrrev_b32 v12, 16, v12
    v_mul_u32_u24 v13, 18, v12
    v_sub_u32 v13, v11, v13
    v_add_u32 v13, s56, v13
    v_subrev_u32 v11, 18, v13
    v_min_u32 v13, v13, v11
    v_mul_u32_u24 v12, s18, v12
    v_lshl_add_u32 v3, v13, 4, v12
    v_subrev_u32 v3, 2048, v3
    v_add_u32 v11, s17, v0
    v_add_u32 v11, 192, v11
    v_mul_u32_u24 v12, 3641, v11
    v_lshrrev_b32 v12, 16, v12
    v_mul_u32_u24 v13, 18, v12
    v_sub_u32 v13, v11, v13
    v_add_u32 v13, s56, v13
    v_subrev_u32 v11, 18, v13
    v_min_u32 v13, v13, v11
    v_mul_u32_u24 v12, s18, v12
    v_lshl_add_u32 v4, v13, 4, v12
    v_subrev_u32 v4, 3072, v4
    v_add_u32 v11, s17, v0
    v_add_u32 v11, 256, v11
    v_mul_u32_u24 v12, 3641, v11
    v_lshrrev_b32 v12, 16, v12
    v_mul_u32_u24 v13, 18, v12
    v_sub_u32 v13, v11, v13
    v_add_u32 v13, s56, v13
    v_subrev_u32 v11, 18, v13
    v_min_u32 v13, v13, v11
    v_mul_u32_u24 v12, s18, v12
    v_lshl_add_u32 v5, v13, 4, v12
    s_cmp_ge_u32 s14, 2
    s_cselect_b32 s19, 1, 0
    v_mov_b32 v11, 0x7f000000
    s_cselect_b64 vcc, -1, 0
    v_cndmask_b32 v5, v5, v11, vcc
    s_mul_i32 s32, s12, 288
    s_mul_i32 s33, s13, 36864
    s_cmp_ge_u32 s3, 4
    s_cselect_b32 s4, s6, s4
    s_cselect_b32 s5, s7, s5
    s_cselect_b32 s16, 18560, 0
    s_lshl_b32 s17, s15, 10
    s_add_u32 s16, s16, s17
    s_add_u32 s35, s16, 4096
    s_mov_b32 s6, 5308416
    s_mov_b32 s7, 0x00020000
    s_add_u32 s24, s10, 12582912
    s_addc_u32 s25, s11, 0
    s_mov_b32 s26, 2359296
    s_mov_b32 s27, 0x00020000
    s_add_u32 s48, s10, 8388608
    s_addc_u32 s49, s11, 0
    s_mov_b32 s50, 2359296
    s_mov_b32 s51, 0x00020000
    s_add_u32 s52, s10, 66060288
    s_addc_u32 s53, s11, 0
    s_mov_b32 s54, 45056
    s_mov_b32 s55, 0x00020000
    s_lshl_b32 s17, s43, 2
    s_add_u32 s17, s17, s14
    s_mul_i32 s17, s17, 30
    v_add_u32 v11, s17, v0
    v_mul_u32_u24 v12, 21846, v11
    v_lshrrev_b32 v12, 16, v12
    v_mul_u32_u24 v13, 3, v12
    v_sub_u32 v13, v11, v13
    s_movk_i32 s18, 9216
    v_mul_u32_u24 v12, s18, v12
    v_lshl_add_u32 v14, v13, 7, v12
    s_mul_i32 s34, s12, 288
    s_add_u32 s34, s34, 2359296
    s_mov_b32 s41, s34
    v_mov_b32 v23, v14
    v_lshrrev_b32 v217, 4, v0
    v_lshlrev_b32 v217, 8, v217
    v_bfe_u32 v12, v0, 1, 1
    v_lshl_add_u32 v217, v12, 7, v217
    v_bfe_u32 v12, v0, 2, 2
    v_lshl_add_u32 v217, v12, 4, v217
    v_and_b32 v12, 1, v0
    v_lshl_add_u32 v217, v12, 3, v217
    v_add_u32 v217, s38, v217
    s_lshr_b32 s36, s39, 2
    s_mul_i32 s36, s36, 36864
    s_and_b32 s17, s39, 3
    s_lshl_b32 s17, s17, 7
    s_add_u32 s36, s36, s17
    s_lshl_b32 s17, s3, 12
    s_add_u32 s37, s36, s17
    v_lshrrev_b32 v218, 1, v213
    v_lshlrev_b32 v218, 10, v218
    v_and_b32 v13, 1, v213
    v_lshl_add_u32 v218, v13, 9, v218
    v_lshl_add_u32 v218, v212, 4, v218
    v_lshlrev_b32 v220, 6, v212
    v_add_u32 v220, 159744, v220
    s_lshl_b32 s17, s3, 3
    v_add_u32 v219, s17, v220
    s_mov_b32 s56, 0xffff0000
    s_mov_b32 s57, 0x3ae38e39
    s_mov_b32 s42, 0x3727c5ac
    s_cmp_ge_u32 s2, 144
    s_cbranch_scc1 KB_ca
    s_load_dwordx2 s[8:9], s[0:1], 40
    s_and_b32 s17, s2, 7
    s_mul_i32 s17, s17, 18
    s_lshr_b32 s18, s2, 3
    s_add_u32 s17, s17, s18
    s_lshr_b32 s15, s3, 1
    s_and_b32 s40, s3, 1
    s_lshl_b32 s41, s17, 2
    s_add_u32 s17, s41, s15
    s_mul_i32 s88, s15, 22528
    s_add_u32 s88, s88, 40960
    s_lshl_b32 s89, s17, 12
    s_lshl_b32 s90, s17, 1
    s_lshl_b32 s18, s40, 11
    s_add_u32 s89, s89, s18
    v_mov_b32 v9, 0
    v_lshrrev_b32 v23, 2, v0
    s_movk_i32 s18, 9216
    v_mul_u32_u24 v23, s18, v23
    v_and_b32 v14, 3, v0
    v_lshl_add_u32 v23, v14, 4, v23
    s_mul_i32 s91, s3, 294912
    s_lshl_b32 s18, s41, 4
    s_add_u32 s91, s91, s18
    s_add_u32 s92, s91, 147456
    s_movk_i32 s18, 4416
    s_lshl_b32 s17, s40, 6
    s_add_u32 s17, s17, s88
    v_and_b32 v20, 3, v0
    v_mul_u32_u24 v20, s18, v20
    v_bfe_u32 v21, v0, 2, 2
    v_lshrrev_b32 v18, 4, v0
    v_add_u32 v21, v21, v18
    v_lshl_add_u32 v20, v21, 4, v20
    v_add_u32 v20, s17, v20
    v_and_b32 v10, 1, v0
    v_bfe_u32 v11, v0, 1, 3
    v_lshlrev_b32 v21, 4, v18
    v_lshlrev_b32 v16, 6, v11
    v_sub_u32 v21, v21, v16
    v_lshlrev_b32 v17, 3, v10
    v_sub_u32 v21, v21, v17
    v_add_u32 v21, 18128, v21
    v_add_u32 v21, s17, v21
    s_mov_b32 s96, s10
    s_mov_b32 s97, s11
    s_mov_b32 s98, 2359296
    s_mov_b32 s99, 0x00020000
    v_mov_b32 v24, 0
    v_mov_b32 v25, 0
    v_mov_b32 v26, 0
    v_mov_b32 v27, 0
    v_mov_b32 v28, 0
    v_mov_b32 v29, 0
    v_mov_b32 v30, 0
    v_mov_b32 v31, 0
    v_mov_b32 v32, 0
    v_mov_b32 v33, 0
    v_mov_b32 v34, 0
    v_mov_b32 v35, 0
    v_mov_b32 v36, 0
    v_mov_b32 v37, 0
    v_mov_b32 v38, 0
    v_mov_b32 v39, 0
    v_mov_b32 v40, 0
    v_mov_b32 v41, 0
    v_mov_b32 v42, 0
    v_mov_b32 v43, 0
    v_mov_b32 v44, 0
    v_mov_b32 v45, 0
    v_mov_b32 v46, 0
    v_mov_b32 v47, 0
    v_mov_b32 v48, 0
    v_mov_b32 v49, 0
    v_mov_b32 v50, 0
    v_mov_b32 v51, 0
    v_mov_b32 v52, 0
    v_mov_b32 v53, 0
    v_mov_b32 v54, 0
    v_mov_b32 v55, 0
    s_lshr_b32 s17, s41, 5
    s_lshl_b32 s17, s17, 7
    s_add_u32 s17, s17, 40960
    s_waitcnt lgkmcnt(0)
    s_mov_b32 s20, s8
    s_mov_b32 s21, s9
    s_mov_b32 s22, 1152
    s_mov_b32 s23, 0x00020000
    s_cmp_lg_u32 s3, 0
    s_cbranch_scc1 M_np
    s_mov_b32 s58, 0
M_poll:
    buffer_load_dword v12, v9, s[52:55], s17 offen sc1
    s_waitcnt vmcnt(0)
    s_add_u32 s58, s58, 1
    v_readfirstlane_b32 s59, v12
    s_nop 0
    s_cmp_ge_u32 s59, 32
    s_cbranch_scc1 M_np
    s_cmp_lt_u32 s58, 0x40000
    s_cbranch_scc0 M_np
    s_sleep 1
    s_branch M_poll
M_np:
    s_waitcnt vmcnt(0)
    s_barrier
    s_lshl_b32 s17, s40, 11
    s_add_u32 s17, s17, s88
    s_add_u32 m0, s17, 17680
    s_nop 0
    buffer_load_dwordx4 v8, s[96:99], s89 offen sc1 lds
    buffer_load_dwordx4 v8, s[96:99], s89 offen offset:1024 sc1 lds
    buffer_load_ushort v19, v9, s[20:23], s90 offen
    s_branch KB_cb
KB_ca:
    s_waitcnt vmcnt(0)
KB_cb:
    v_lshlrev_b32 v132, 16, v224
    v_and_b32 v133, s56, v224
    v_lshlrev_b32 v134, 16, v225
    v_and_b32 v135, s56, v225
    v_lshlrev_b32 v136, 16, v226
    v_and_b32 v137, s56, v226
    v_lshlrev_b32 v138, 16, v227
    v_and_b32 v139, s56, v227
    v_lshlrev_b32 v140, 16, v228
    v_add_f32 v156, v132, v133
    v_mul_f32 v157, v132, v132
    v_fmac_f32 v157, v133, v133
    v_add_f32 v156, v156, v134
    v_fmac_f32 v157, v134, v134
    v_add_f32 v156, v156, v135
    v_fmac_f32 v157, v135, v135
    v_add_f32 v156, v156, v136
    v_fmac_f32 v157, v136, v136
    v_add_f32 v156, v156, v137
    v_fmac_f32 v157, v137, v137
    v_add_f32 v156, v156, v138
    v_fmac_f32 v157, v138, v138
    v_add_f32 v156, v156, v139
    v_fmac_f32 v157, v139, v139
    v_add_f32 v156, v156, v140
    v_fmac_f32 v157, v140, v140
    s_nop 0
    v_add_f32_dpp v156, v156, v156 row_ror:8 row_mask:0xf bank_mask:0xf
    v_add_f32_dpp v157, v157, v157 row_ror:8 row_mask:0xf bank_mask:0xf
    v_mov_b32 v158, v156
    v_mov_b32 v159, v157
    s_nop 0
    v_permlane16_swap_b32 v156, v158
    v_permlane16_swap_b32 v157, v159
    v_add_f32 v156, v156, v158
    v_add_f32 v157, v157, v159
    v_mov_b32 v158, v156
    v_mov_b32 v159, v157
    s_nop 0
    v_permlane32_swap_b32 v156, v158
    v_permlane32_swap_b32 v157, v159
    v_add_f32 v156, v156, v158
    v_add_f32 v157, v157, v159
    s_mov_b64 exec, 0xff
    ds_write_b64 v219, v[156:157] offset:0
    s_mov_b64 exec, -1
    s_waitcnt lgkmcnt(0)
    s_barrier
    ds_read_b128 v[164:167], v220 offset:0
    ds_read_b128 v[168:171], v220 offset:16
    ds_read_b128 v[172:175], v220 offset:32
    ds_read_b128 v[176:179], v220 offset:48
    s_waitcnt lgkmcnt(0)
    v_pk_add_f32 v[164:165], v[164:165], v[166:167]
    v_pk_add_f32 v[168:169], v[168:169], v[170:171]
    v_pk_add_f32 v[172:173], v[172:173], v[174:175]
    v_pk_add_f32 v[176:177], v[176:177], v[178:179]
    v_pk_add_f32 v[164:165], v[164:165], v[168:169]
    v_pk_add_f32 v[172:173], v[172:173], v[176:177]
    v_pk_add_f32 v[164:165], v[164:165], v[172:173]
    v_mul_f32 v230, s57, v164
    v_mul_f32 v231, s57, v165
    v_fma_f32 v231, -v230, v230, v231
    v_max_f32 v231, 0, v231
    v_cvt_pk_bf16_f32 v158, v230, v231
    v_lshlrev_b32 v230, 16, v158
    v_and_b32 v231, s56, v158
    v_add_f32 v231, s42, v231
    v_cvt_pk_bf16_f32 v231, v231, v231
    v_and_b32 v231, s56, v231
    v_sqrt_f32 v231, v231
    s_nop 0
    v_cvt_pk_bf16_f32 v231, v231, v231
    v_and_b32 v231, s56, v231
    v_rcp_f32 v231, v231
    s_cmp_lt_u32 s2, 144
    s_cbranch_scc1 KB_nd
    s_add_u32 m0, s16, 0
    s_nop 0
    buffer_load_dwordx4 v1, s[4:7], s32 offen lds
    buffer_load_dwordx4 v2, s[4:7], s32 offen offset:1024 lds
    buffer_load_dwordx4 v3, s[4:7], s32 offen offset:2048 lds
    buffer_load_dwordx4 v4, s[4:7], s32 offen offset:3072 lds
    s_add_u32 s34, s35, 0
    s_cmp_eq_u32 s19, 1
    s_cselect_b32 m0, 148480, s34
    s_nop 0
    buffer_load_dwordx4 v5, s[4:7], s32 offen lds
    s_add_u32 s32, s32, 589824
    s_add_u32 m0, s16, 37120
    s_nop 0
    buffer_load_dwordx4 v1, s[4:7], s32 offen lds
    buffer_load_dwordx4 v2, s[4:7], s32 offen offset:1024 lds
    buffer_load_dwordx4 v3, s[4:7], s32 offen offset:2048 lds
    buffer_load_dwordx4 v4, s[4:7], s32 offen offset:3072 lds
    s_add_u32 s34, s35, 37120
    s_cmp_eq_u32 s19, 1
    s_cselect_b32 m0, 148480, s34
    s_nop 0
    buffer_load_dwordx4 v5, s[4:7], s32 offen lds
    s_add_u32 s32, s32, 589824
    s_add_u32 m0, s16, 74240
    s_nop 0
    buffer_load_dwordx4 v1, s[4:7], s32 offen lds
    buffer_load_dwordx4 v2, s[4:7], s32 offen offset:1024 lds
    buffer_load_dwordx4 v3, s[4:7], s32 offen offset:2048 lds
    buffer_load_dwordx4 v4, s[4:7], s32 offen offset:3072 lds
    s_add_u32 s34, s35, 74240
    s_cmp_eq_u32 s19, 1
    s_cselect_b32 m0, 148480, s34
    s_nop 0
    buffer_load_dwordx4 v5, s[4:7], s32 offen lds
    s_add_u32 s32, s32, 589824
    s_add_u32 m0, s16, 111360
    s_nop 0
    buffer_load_dwordx4 v1, s[4:7], s32 offen lds
    buffer_load_dwordx4 v2, s[4:7], s32 offen offset:1024 lds
    buffer_load_dwordx4 v3, s[4:7], s32 offen offset:2048 lds
    buffer_load_dwordx4 v4, s[4:7], s32 offen offset:3072 lds
    s_add_u32 s34, s35, 111360
    s_cmp_eq_u32 s19, 1
    s_cselect_b32 m0, 148480, s34
    s_nop 0
    buffer_load_dwordx4 v5, s[4:7], s32 offen lds
    s_add_u32 s32, s32, 589824
    s_sub_u32 s17, s2, 144
    s_lshl_b32 s17, s17, 3
    s_add_u32 s17, s17, s3
    s_mul_i32 s18, s17, 5952
    s_mov_b32 s20, s44
    s_mov_b32 s21, s45
    s_mov_b32 s22, 5308416
    s_mov_b32 s23, 0x00020000
    v_lshlrev_b32 v12, 3, v8
    s_mov_b32 exec_hi, 0xffff
    buffer_load_dword v13, v12, s[20:23], s18 offen
    s_mov_b64 exec, -1
    s_add_u32 s96, s10, 50331648
    s_addc_u32 s97, s11, 0
    s_mov_b32 s98, 4792320
    s_mov_b32 s99, 0x00020000
    s_mul_i32 s17, s17, 6144
    s_add_u32 s18, s17, 4096
    v_mov_b32 v16, -1
    v_mov_b32 v17, -1
    v_mov_b32 v18, -1
    v_mov_b32 v19, -1
    buffer_store_dwordx4 v[16:19], v8, s[96:99], s17 offen offset:0 sc1
    buffer_store_dwordx4 v[16:19], v8, s[96:99], s17 offen offset:1024 sc1
    buffer_store_dwordx4 v[16:19], v8, s[96:99], s17 offen offset:2048 sc1
    buffer_store_dwordx4 v[16:19], v8, s[96:99], s17 offen offset:3072 sc1
    buffer_store_dwordx4 v[16:19], v8, s[96:99], s18 offen offset:0 sc1
    buffer_store_dwordx4 v[16:19], v8, s[96:99], s18 offen offset:1024 sc1
    s_branch KB_nc
KB_nd:
    s_waitcnt vmcnt(1) lgkmcnt(0)
    s_barrier
    ds_read_b128 v[56:59], v20 offset:0
    ds_read_b64 v[192:193], v21 offset:3584
    ds_read_b64 v[194:195], v21 offset:3592
    ds_read_b64 v[176:177], v21 offset:3072
    ds_read_b64 v[178:179], v21 offset:3080
    ds_read_b64 v[160:161], v21 offset:2560
    ds_read_b64 v[162:163], v21 offset:2568
    ds_read_b64 v[144:145], v21 offset:2048
    ds_read_b64 v[146:147], v21 offset:2056
    ds_read_b64 v[128:129], v21 offset:1536
    ds_read_b64 v[130:131], v21 offset:1544
    ds_read_b64 v[112:113], v21 offset:1024
    ds_read_b64 v[114:115], v21 offset:1032
    ds_read_b64 v[96:97], v21 offset:512
    ds_read_b64 v[98:99], v21 offset:520
    ds_read_b64 v[80:81], v21 offset:0
    ds_read_b64 v[82:83], v21 offset:8
    ds_read_b128 v[60:63], v20 offset:128
    ds_read_b128 v[64:67], v20 offset:256
    s_waitcnt lgkmcnt(14)
    v_mfma_f32_16x16x32_bf16 v[24:27], v[56:59], v[192:195], v[24:27]
    ds_read_b64 v[196:197], v21 offset:3712
    ds_read_b64 v[198:199], v21 offset:3720
    ds_read_b64 v[180:181], v21 offset:3200
    ds_read_b64 v[182:183], v21 offset:3208
    v_mfma_f32_16x16x32_bf16 v[28:31], v[56:59], v[176:179], v[28:31]
    ds_read_b64 v[164:165], v21 offset:2688
    ds_read_b64 v[166:167], v21 offset:2696
    s_waitcnt lgkmcnt(14)
    v_mfma_f32_16x16x32_bf16 v[32:35], v[56:59], v[160:163], v[32:35]
    ds_read_b64 v[148:149], v21 offset:2176
    ds_read_b64 v[150:151], v21 offset:2184
    v_mfma_f32_16x16x32_bf16 v[36:39], v[56:59], v[144:147], v[36:39]
    ds_read_b64 v[132:133], v21 offset:1664
    ds_read_b64 v[134:135], v21 offset:1672
    v_mfma_f32_16x16x32_bf16 v[40:43], v[56:59], v[128:131], v[40:43]
    ds_read_b64 v[116:117], v21 offset:1152
    ds_read_b64 v[118:119], v21 offset:1160
    s_waitcnt lgkmcnt(14)
    v_mfma_f32_16x16x32_bf16 v[44:47], v[56:59], v[112:115], v[44:47]
    ds_read_b64 v[100:101], v21 offset:640
    ds_read_b64 v[102:103], v21 offset:648
    v_mfma_f32_16x16x32_bf16 v[48:51], v[56:59], v[96:99], v[48:51]
    ds_read_b64 v[84:85], v21 offset:128
    ds_read_b64 v[86:87], v21 offset:136
    v_mfma_f32_16x16x32_bf16 v[52:55], v[56:59], v[80:83], v[52:55]
    ds_read_b128 v[68:71], v20 offset:384
    s_waitcnt lgkmcnt(14)
    v_mfma_f32_16x16x32_bf16 v[24:27], v[60:63], v[196:199], v[24:27]
    ds_read_b64 v[200:201], v21 offset:3840
    ds_read_b64 v[202:203], v21 offset:3848
    ds_read_b64 v[184:185], v21 offset:3328
    ds_read_b64 v[186:187], v21 offset:3336
    s_waitcnt lgkmcnt(14)
    v_mfma_f32_16x16x32_bf16 v[28:31], v[60:63], v[180:183], v[28:31]
    ds_read_b64 v[168:169], v21 offset:2816
    ds_read_b64 v[170:171], v21 offset:2824
    v_mfma_f32_16x16x32_bf16 v[32:35], v[60:63], v[164:167], v[32:35]
    ds_read_b64 v[152:153], v21 offset:2304
    ds_read_b64 v[154:155], v21 offset:2312
    s_waitcnt lgkmcnt(14)
    v_mfma_f32_16x16x32_bf16 v[36:39], v[60:63], v[148:151], v[36:39]
    ds_read_b64 v[136:137], v21 offset:1792
    ds_read_b64 v[138:139], v21 offset:1800
    v_mfma_f32_16x16x32_bf16 v[40:43], v[60:63], v[132:135], v[40:43]
    ds_read_b64 v[120:121], v21 offset:1280
    ds_read_b64 v[122:123], v21 offset:1288
    s_waitcnt lgkmcnt(14)
    v_mfma_f32_16x16x32_bf16 v[44:47], v[60:63], v[116:119], v[44:47]
    ds_read_b64 v[104:105], v21 offset:768
    ds_read_b64 v[106:107], v21 offset:776
    v_mfma_f32_16x16x32_bf16 v[48:51], v[60:63], v[100:103], v[48:51]
    ds_read_b64 v[88:89], v21 offset:256
    ds_read_b64 v[90:91], v21 offset:264
    s_waitcnt lgkmcnt(14)
    v_mfma_f32_16x16x32_bf16 v[52:55], v[60:63], v[84:87], v[52:55]
    ds_read_b128 v[72:75], v20 offset:512
    v_mfma_f32_16x16x32_bf16 v[24:27], v[64:67], v[200:203], v[24:27]
    ds_read_b64 v[204:205], v21 offset:3968
    ds_read_b64 v[206:207], v21 offset:3976
    ds_read_b64 v[188:189], v21 offset:3456
    ds_read_b64 v[190:191], v21 offset:3464
    s_waitcnt lgkmcnt(14)
    v_mfma_f32_16x16x32_bf16 v[28:31], v[64:67], v[184:187], v[28:31]
    ds_read_b64 v[172:173], v21 offset:2944
    ds_read_b64 v[174:175], v21 offset:2952
    v_mfma_f32_16x16x32_bf16 v[32:35], v[64:67], v[168:171], v[32:35]
    ds_read_b64 v[156:157], v21 offset:2432
    ds_read_b64 v[158:159], v21 offset:2440
    s_waitcnt lgkmcnt(14)
    v_mfma_f32_16x16x32_bf16 v[36:39], v[64:67], v[152:155], v[36:39]
    ds_read_b64 v[140:141], v21 offset:1920
    ds_read_b64 v[142:143], v21 offset:1928
    v_mfma_f32_16x16x32_bf16 v[40:43], v[64:67], v[136:139], v[40:43]
    ds_read_b64 v[124:125], v21 offset:1408
    ds_read_b64 v[126:127], v21 offset:1416
    s_waitcnt lgkmcnt(14)
    v_mfma_f32_16x16x32_bf16 v[44:47], v[64:67], v[120:123], v[44:47]
    ds_read_b64 v[108:109], v21 offset:896
    ds_read_b64 v[110:111], v21 offset:904
    v_mfma_f32_16x16x32_bf16 v[48:51], v[64:67], v[104:107], v[48:51]
    ds_read_b64 v[92:93], v21 offset:384
    ds_read_b64 v[94:95], v21 offset:392
    s_waitcnt lgkmcnt(14)
    v_mfma_f32_16x16x32_bf16 v[52:55], v[64:67], v[88:91], v[52:55]
    ds_read_b128 v[76:79], v20 offset:640
    v_mfma_f32_16x16x32_bf16 v[24:27], v[68:71], v[204:207], v[24:27]
    ds_read_b64 v[208:209], v21 offset:4096
    ds_read_b64 v[210:211], v21 offset:4104
    s_waitcnt lgkmcnt(14)
    v_mfma_f32_16x16x32_bf16 v[28:31], v[68:71], v[188:191], v[28:31]
    ds_read_b128 v[56:59], v20 offset:768
    s_waitcnt lgkmcnt(14)
    v_mfma_f32_16x16x32_bf16 v[32:35], v[68:71], v[172:175], v[32:35]
    s_waitcnt lgkmcnt(12)
    v_mfma_f32_16x16x32_bf16 v[36:39], v[68:71], v[156:159], v[36:39]
    s_waitcnt lgkmcnt(10)
    v_mfma_f32_16x16x32_bf16 v[40:43], v[68:71], v[140:143], v[40:43]
    s_waitcnt lgkmcnt(8)
    v_mfma_f32_16x16x32_bf16 v[44:47], v[68:71], v[124:127], v[44:47]
    s_waitcnt lgkmcnt(6)
    v_mfma_f32_16x16x32_bf16 v[48:51], v[68:71], v[108:111], v[48:51]
    s_waitcnt lgkmcnt(4)
    v_mfma_f32_16x16x32_bf16 v[52:55], v[68:71], v[92:95], v[52:55]
    s_waitcnt lgkmcnt(1)
    v_mfma_f32_16x16x32_bf16 v[24:27], v[72:75], v[208:211], v[24:27]
    ds_read_b128 v[60:63], v20 offset:896
    v_mfma_f32_16x16x32_bf16 v[28:31], v[72:75], v[192:195], v[28:31]
    v_mfma_f32_16x16x32_bf16 v[32:35], v[72:75], v[176:179], v[32:35]
    v_mfma_f32_16x16x32_bf16 v[36:39], v[72:75], v[160:163], v[36:39]
    v_mfma_f32_16x16x32_bf16 v[40:43], v[72:75], v[144:147], v[40:43]
    v_mfma_f32_16x16x32_bf16 v[44:47], v[72:75], v[128:131], v[44:47]
    v_mfma_f32_16x16x32_bf16 v[48:51], v[72:75], v[112:115], v[48:51]
    v_mfma_f32_16x16x32_bf16 v[52:55], v[72:75], v[96:99], v[52:55]
    v_mfma_f32_16x16x32_bf16 v[28:31], v[76:79], v[196:199], v[28:31]
    ds_read_b128 v[64:67], v20 offset:1024
    v_mfma_f32_16x16x32_bf16 v[32:35], v[76:79], v[180:183], v[32:35]
    v_mfma_f32_16x16x32_bf16 v[36:39], v[76:79], v[164:167], v[36:39]
    v_mfma_f32_16x16x32_bf16 v[40:43], v[76:79], v[148:151], v[40:43]
    v_mfma_f32_16x16x32_bf16 v[44:47], v[76:79], v[132:135], v[44:47]
    v_mfma_f32_16x16x32_bf16 v[48:51], v[76:79], v[116:119], v[48:51]
    v_mfma_f32_16x16x32_bf16 v[52:55], v[76:79], v[100:103], v[52:55]
    s_waitcnt lgkmcnt(2)
    v_mfma_f32_16x16x32_bf16 v[28:31], v[56:59], v[200:203], v[28:31]
    ds_read_b128 v[68:71], v20 offset:1152
    v_mfma_f32_16x16x32_bf16 v[32:35], v[56:59], v[184:187], v[32:35]
    v_mfma_f32_16x16x32_bf16 v[36:39], v[56:59], v[168:171], v[36:39]
    v_mfma_f32_16x16x32_bf16 v[40:43], v[56:59], v[152:155], v[40:43]
    v_mfma_f32_16x16x32_bf16 v[44:47], v[56:59], v[136:139], v[44:47]
    v_mfma_f32_16x16x32_bf16 v[48:51], v[56:59], v[120:123], v[48:51]
    v_mfma_f32_16x16x32_bf16 v[52:55], v[56:59], v[104:107], v[52:55]
    s_waitcnt lgkmcnt(2)
    v_mfma_f32_16x16x32_bf16 v[28:31], v[60:63], v[204:207], v[28:31]
    ds_read_b128 v[72:75], v20 offset:1280
    v_mfma_f32_16x16x32_bf16 v[32:35], v[60:63], v[188:191], v[32:35]
    v_mfma_f32_16x16x32_bf16 v[36:39], v[60:63], v[172:175], v[36:39]
    v_mfma_f32_16x16x32_bf16 v[40:43], v[60:63], v[156:159], v[40:43]
    v_mfma_f32_16x16x32_bf16 v[44:47], v[60:63], v[140:143], v[44:47]
    v_mfma_f32_16x16x32_bf16 v[48:51], v[60:63], v[124:127], v[48:51]
    v_mfma_f32_16x16x32_bf16 v[52:55], v[60:63], v[108:111], v[52:55]
    s_waitcnt lgkmcnt(2)
    v_mfma_f32_16x16x32_bf16 v[28:31], v[64:67], v[208:211], v[28:31]
    ds_read_b128 v[76:79], v20 offset:1408
    v_mfma_f32_16x16x32_bf16 v[32:35], v[64:67], v[192:195], v[32:35]
    v_mfma_f32_16x16x32_bf16 v[36:39], v[64:67], v[176:179], v[36:39]
    v_mfma_f32_16x16x32_bf16 v[40:43], v[64:67], v[160:163], v[40:43]
    v_mfma_f32_16x16x32_bf16 v[44:47], v[64:67], v[144:147], v[44:47]
    v_mfma_f32_16x16x32_bf16 v[48:51], v[64:67], v[128:131], v[48:51]
    v_mfma_f32_16x16x32_bf16 v[52:55], v[64:67], v[112:115], v[52:55]
    s_waitcnt lgkmcnt(2)
    v_mfma_f32_16x16x32_bf16 v[32:35], v[68:71], v[196:199], v[32:35]
    ds_read_b128 v[56:59], v20 offset:1536
    v_mfma_f32_16x16x32_bf16 v[36:39], v[68:71], v[180:183], v[36:39]
    v_mfma_f32_16x16x32_bf16 v[40:43], v[68:71], v[164:167], v[40:43]
    v_mfma_f32_16x16x32_bf16 v[44:47], v[68:71], v[148:151], v[44:47]
    v_mfma_f32_16x16x32_bf16 v[48:51], v[68:71], v[132:135], v[48:51]
    v_mfma_f32_16x16x32_bf16 v[52:55], v[68:71], v[116:119], v[52:55]
    s_waitcnt lgkmcnt(2)
    v_mfma_f32_16x16x32_bf16 v[32:35], v[72:75], v[200:203], v[32:35]
    ds_read_b128 v[60:63], v20 offset:1664
    v_mfma_f32_16x16x32_bf16 v[36:39], v[72:75], v[184:187], v[36:39]
    v_mfma_f32_16x16x32_bf16 v[40:43], v[72:75], v[168:171], v[40:43]
    v_mfma_f32_16x16x32_bf16 v[44:47], v[72:75], v[152:155], v[44:47]
    v_mfma_f32_16x16x32_bf16 v[48:51], v[72:75], v[136:139], v[48:51]
    v_mfma_f32_16x16x32_bf16 v[52:55], v[72:75], v[120:123], v[52:55]
    s_waitcnt lgkmcnt(2)
    v_mfma_f32_16x16x32_bf16 v[32:35], v[76:79], v[204:207], v[32:35]
    ds_read_b128 v[64:67], v20 offset:1792
    v_mfma_f32_16x16x32_bf16 v[36:39], v[76:79], v[188:191], v[36:39]
    v_mfma_f32_16x16x32_bf16 v[40:43], v[76:79], v[172:175], v[40:43]
    v_mfma_f32_16x16x32_bf16 v[44:47], v[76:79], v[156:159], v[44:47]
    v_mfma_f32_16x16x32_bf16 v[48:51], v[76:79], v[140:143], v[48:51]
    v_mfma_f32_16x16x32_bf16 v[52:55], v[76:79], v[124:127], v[52:55]
    s_waitcnt lgkmcnt(2)
    v_mfma_f32_16x16x32_bf16 v[32:35], v[56:59], v[208:211], v[32:35]
    ds_read_b128 v[68:71], v20 offset:1920
    v_mfma_f32_16x16x32_bf16 v[36:39], v[56:59], v[192:195], v[36:39]
    v_mfma_f32_16x16x32_bf16 v[40:43], v[56:59], v[176:179], v[40:43]
    v_mfma_f32_16x16x32_bf16 v[44:47], v[56:59], v[160:163], v[44:47]
    v_mfma_f32_16x16x32_bf16 v[48:51], v[56:59], v[144:147], v[48:51]
    v_mfma_f32_16x16x32_bf16 v[52:55], v[56:59], v[128:131], v[52:55]
    s_waitcnt lgkmcnt(2)
    v_mfma_f32_16x16x32_bf16 v[36:39], v[60:63], v[196:199], v[36:39]
    ds_read_b128 v[72:75], v20 offset:2048
    v_mfma_f32_16x16x32_bf16 v[40:43], v[60:63], v[180:183], v[40:43]
    v_mfma_f32_16x16x32_bf16 v[44:47], v[60:63], v[164:167], v[44:47]
    v_mfma_f32_16x16x32_bf16 v[48:51], v[60:63], v[148:151], v[48:51]
    v_mfma_f32_16x16x32_bf16 v[52:55], v[60:63], v[132:135], v[52:55]
    s_waitcnt lgkmcnt(2)
    v_mfma_f32_16x16x32_bf16 v[36:39], v[64:67], v[200:203], v[36:39]
    ds_read_b128 v[76:79], v20 offset:2176
    v_mfma_f32_16x16x32_bf16 v[40:43], v[64:67], v[184:187], v[40:43]
    v_mfma_f32_16x16x32_bf16 v[44:47], v[64:67], v[168:171], v[44:47]
    v_mfma_f32_16x16x32_bf16 v[48:51], v[64:67], v[152:155], v[48:51]
    v_mfma_f32_16x16x32_bf16 v[52:55], v[64:67], v[136:139], v[52:55]
    s_waitcnt lgkmcnt(2)
    v_mfma_f32_16x16x32_bf16 v[36:39], v[68:71], v[204:207], v[36:39]
    ds_read_b128 v[56:59], v20 offset:2304
    v_mfma_f32_16x16x32_bf16 v[40:43], v[68:71], v[188:191], v[40:43]
    v_mfma_f32_16x16x32_bf16 v[44:47], v[68:71], v[172:175], v[44:47]
    v_mfma_f32_16x16x32_bf16 v[48:51], v[68:71], v[156:159], v[48:51]
    v_mfma_f32_16x16x32_bf16 v[52:55], v[68:71], v[140:143], v[52:55]
    s_waitcnt lgkmcnt(2)
    v_mfma_f32_16x16x32_bf16 v[36:39], v[72:75], v[208:211], v[36:39]
    ds_read_b128 v[60:63], v20 offset:2432
    v_mfma_f32_16x16x32_bf16 v[40:43], v[72:75], v[192:195], v[40:43]
    v_mfma_f32_16x16x32_bf16 v[44:47], v[72:75], v[176:179], v[44:47]
    v_mfma_f32_16x16x32_bf16 v[48:51], v[72:75], v[160:163], v[48:51]
    v_mfma_f32_16x16x32_bf16 v[52:55], v[72:75], v[144:147], v[52:55]
    s_waitcnt lgkmcnt(2)
    v_mfma_f32_16x16x32_bf16 v[40:43], v[76:79], v[196:199], v[40:43]
    ds_read_b128 v[64:67], v20 offset:2560
    v_mfma_f32_16x16x32_bf16 v[44:47], v[76:79], v[180:183], v[44:47]
    v_mfma_f32_16x16x32_bf16 v[48:51], v[76:79], v[164:167], v[48:51]
    v_mfma_f32_16x16x32_bf16 v[52:55], v[76:79], v[148:151], v[52:55]
    s_waitcnt lgkmcnt(2)
    v_mfma_f32_16x16x32_bf16 v[40:43], v[56:59], v[200:203], v[40:43]
    ds_read_b128 v[68:71], v20 offset:2688
    v_mfma_f32_16x16x32_bf16 v[44:47], v[56:59], v[184:187], v[44:47]
    v_mfma_f32_16x16x32_bf16 v[48:51], v[56:59], v[168:171], v[48:51]
    v_mfma_f32_16x16x32_bf16 v[52:55], v[56:59], v[152:155], v[52:55]
    s_waitcnt lgkmcnt(2)
    v_mfma_f32_16x16x32_bf16 v[40:43], v[60:63], v[204:207], v[40:43]
    ds_read_b128 v[72:75], v20 offset:2816
    v_mfma_f32_16x16x32_bf16 v[44:47], v[60:63], v[188:191], v[44:47]
    v_mfma_f32_16x16x32_bf16 v[48:51], v[60:63], v[172:175], v[48:51]
    v_mfma_f32_16x16x32_bf16 v[52:55], v[60:63], v[156:159], v[52:55]
    s_waitcnt lgkmcnt(2)
    v_mfma_f32_16x16x32_bf16 v[40:43], v[64:67], v[208:211], v[40:43]
    ds_read_b128 v[76:79], v20 offset:2944
    v_mfma_f32_16x16x32_bf16 v[44:47], v[64:67], v[192:195], v[44:47]
    v_mfma_f32_16x16x32_bf16 v[48:51], v[64:67], v[176:179], v[48:51]
    v_mfma_f32_16x16x32_bf16 v[52:55], v[64:67], v[160:163], v[52:55]
    s_waitcnt lgkmcnt(2)
    v_mfma_f32_16x16x32_bf16 v[44:47], v[68:71], v[196:199], v[44:47]
    ds_read_b128 v[56:59], v20 offset:3072
    v_mfma_f32_16x16x32_bf16 v[48:51], v[68:71], v[180:183], v[48:51]
    v_mfma_f32_16x16x32_bf16 v[52:55], v[68:71], v[164:167], v[52:55]
    s_waitcnt lgkmcnt(2)
    v_mfma_f32_16x16x32_bf16 v[44:47], v[72:75], v[200:203], v[44:47]
    ds_read_b128 v[60:63], v20 offset:3200
    v_mfma_f32_16x16x32_bf16 v[48:51], v[72:75], v[184:187], v[48:51]
    v_mfma_f32_16x16x32_bf16 v[52:55], v[72:75], v[168:171], v[52:55]
    s_waitcnt lgkmcnt(2)
    v_mfma_f32_16x16x32_bf16 v[44:47], v[76:79], v[204:207], v[44:47]
    ds_read_b128 v[64:67], v20 offset:3328
    v_mfma_f32_16x16x32_bf16 v[48:51], v[76:79], v[188:191], v[48:51]
    v_mfma_f32_16x16x32_bf16 v[52:55], v[76:79], v[172:175], v[52:55]
    s_waitcnt lgkmcnt(2)
    v_mfma_f32_16x16x32_bf16 v[44:47], v[56:59], v[208:211], v[44:47]
    ds_read_b128 v[68:71], v20 offset:3456
    v_mfma_f32_16x16x32_bf16 v[48:51], v[56:59], v[192:195], v[48:51]
    v_mfma_f32_16x16x32_bf16 v[52:55], v[56:59], v[176:179], v[52:55]
    s_waitcnt lgkmcnt(2)
    v_mfma_f32_16x16x32_bf16 v[48:51], v[60:63], v[196:199], v[48:51]
    ds_read_b128 v[72:75], v20 offset:3584
    v_mfma_f32_16x16x32_bf16 v[52:55], v[60:63], v[180:183], v[52:55]
    s_waitcnt lgkmcnt(2)
    v_mfma_f32_16x16x32_bf16 v[48:51], v[64:67], v[200:203], v[48:51]
    ds_read_b128 v[76:79], v20 offset:3712
    v_mfma_f32_16x16x32_bf16 v[52:55], v[64:67], v[184:187], v[52:55]
    s_waitcnt lgkmcnt(2)
    v_mfma_f32_16x16x32_bf16 v[48:51], v[68:71], v[204:207], v[48:51]
    ds_read_b128 v[56:59], v20 offset:3840
    v_mfma_f32_16x16x32_bf16 v[52:55], v[68:71], v[188:191], v[52:55]
    s_waitcnt lgkmcnt(2)
    v_mfma_f32_16x16x32_bf16 v[48:51], v[72:75], v[208:211], v[48:51]
    ds_read_b128 v[60:63], v20 offset:3968
    v_mfma_f32_16x16x32_bf16 v[52:55], v[72:75], v[192:195], v[52:55]
    s_waitcnt lgkmcnt(2)
    v_mfma_f32_16x16x32_bf16 v[52:55], v[76:79], v[196:199], v[52:55]
    ds_read_b128 v[64:67], v20 offset:4096
    s_waitcnt lgkmcnt(2)
    v_mfma_f32_16x16x32_bf16 v[52:55], v[56:59], v[200:203], v[52:55]
    s_waitcnt lgkmcnt(1)
    v_mfma_f32_16x16x32_bf16 v[52:55], v[60:63], v[204:207], v[52:55]
    s_waitcnt lgkmcnt(0)
    v_mfma_f32_16x16x32_bf16 v[52:55], v[64:67], v[208:211], v[52:55]
    s_cmp_lg_u32 s3, 0
    s_cbranch_scc1 M_na
    v_lshlrev_b32 v12, 7, v0
    s_mov_b32 s17, 40960
    s_mov_b32 s58, 0
M_alm:
    s_mov_b64 exec, 0x3ffff
    buffer_load_dword v13, v12, s[52:55], s17 offen sc1
    s_waitcnt vmcnt(0)
    v_cmp_gt_u32 vcc, 32, v13
    s_mov_b64 exec, -1
    s_add_u32 s58, s58, 1
    s_and_b32 s59, vcc_lo, 0x3ffff
    s_cbranch_scc0 M_agm
    s_cmp_lt_u32 s58, 0x40000
    s_cbranch_scc0 M_agm
    s_sleep 4
    s_branch M_alm
M_agm:
M_na:
    s_lshl_b32 s17, s3, 12
    v_add_u32 v12, s17, v8
    s_xor_b32 s17, s17, 4096
    v_add_u32 v13, s17, v8
    v_lshl_add_u32 v14, v18, 4, v16
    v_add_u32 v14, v14, v17
    s_lshl_b32 s17, s40, 11
    s_sub_u32 s17, s88, s17
    s_add_u32 s17, s17, 20232
    v_sub_u32 v14, s17, v14
    v_lshl_add_u32 v15, v11, 2, v18
    v_lshlrev_b32 v15, 6, v15
    v_add_u32 v15, v15, v17
    s_lshl_b32 s17, s40, 13
    s_lshl_b32 s18, s15, 4
    s_add_u32 s17, s17, s18
    s_add_u32 s17, s17, 131072
    v_add_u32 v15, s17, v15
    s_mov_b32 s18, 0xffff0000
    s_lshl_b32 s17, s3, 11
    s_add_u32 s17, s17, 131072
    v_add_u32 v22, s17, v8
    ds_read_b64 v[88:89], v14 offset:1536
    ds_read_b64 v[90:91], v14 offset:1024
    ds_read_b64 v[92:93], v14 offset:512
    ds_read_b64 v[94:95], v14 offset:0
    s_cmp_eq_u32 s40, 0
    s_cbranch_scc1 M_p0
    ds_write_b128 v12, v[24:27] offset:0
    ds_write_b128 v12, v[28:31] offset:1024
    ds_write_b128 v12, v[32:35] offset:2048
    ds_write_b128 v12, v[36:39] offset:3072
    v_mov_b32 v56, v40
    v_mov_b32 v57, v41
    v_mov_b32 v58, v42
    v_mov_b32 v59, v43
    v_mov_b32 v60, v44
    v_mov_b32 v61, v45
    v_mov_b32 v62, v46
    v_mov_b32 v63, v47
    v_mov_b32 v64, v48
    v_mov_b32 v65, v49
    v_mov_b32 v66, v50
    v_mov_b32 v67, v51
    v_mov_b32 v68, v52
    v_mov_b32 v69, v53
    v_mov_b32 v70, v54
    v_mov_b32 v71, v55
    s_branch M_p1
M_p0:
    ds_write_b128 v12, v[40:43] offset:0
    ds_write_b128 v12, v[44:47] offset:1024
    ds_write_b128 v12, v[48:51] offset:2048
    ds_write_b128 v12, v[52:55] offset:3072
    v_mov_b32 v56, v24
    v_mov_b32 v57, v25
    v_mov_b32 v58, v26
    v_mov_b32 v59, v27
    v_mov_b32 v60, v28
    v_mov_b32 v61, v29
    v_mov_b32 v62, v30
    v_mov_b32 v63, v31
    v_mov_b32 v64, v32
    v_mov_b32 v65, v33
    v_mov_b32 v66, v34
    v_mov_b32 v67, v35
    v_mov_b32 v68, v36
    v_mov_b32 v69, v37
    v_mov_b32 v70, v38
    v_mov_b32 v71, v39
M_p1:
    s_waitcnt vmcnt(0) lgkmcnt(0)
    v_lshlrev_b32 v19, 16, v19
    s_barrier
    ds_read_b128 v[72:75], v13 offset:0
    ds_read_b128 v[76:79], v13 offset:1024
    ds_read_b128 v[80:83], v13 offset:2048
    ds_read_b128 v[84:87], v13 offset:3072
    v_and_b32 v96, s18, v89
    v_lshlrev_b32 v97, 16, v89
    v_and_b32 v98, s18, v88
    v_lshlrev_b32 v99, 16, v88
    v_fmac_f32 v56, v19, v96
    v_fmac_f32 v57, v19, v97
    v_fmac_f32 v58, v19, v98
    v_fmac_f32 v59, v19, v99
    v_and_b32 v100, s18, v91
    v_lshlrev_b32 v101, 16, v91
    v_and_b32 v102, s18, v90
    v_lshlrev_b32 v103, 16, v90
    v_fmac_f32 v60, v19, v100
    v_fmac_f32 v61, v19, v101
    v_fmac_f32 v62, v19, v102
    v_fmac_f32 v63, v19, v103
    v_and_b32 v104, s18, v93
    v_lshlrev_b32 v105, 16, v93
    v_and_b32 v106, s18, v92
    v_lshlrev_b32 v107, 16, v92
    v_fmac_f32 v64, v19, v104
    v_fmac_f32 v65, v19, v105
    v_fmac_f32 v66, v19, v106
    v_fmac_f32 v67, v19, v107
    v_and_b32 v108, s18, v95
    v_lshlrev_b32 v109, 16, v95
    v_and_b32 v110, s18, v94
    v_lshlrev_b32 v111, 16, v94
    v_fmac_f32 v68, v19, v108
    v_fmac_f32 v69, v19, v109
    v_fmac_f32 v70, v19, v110
    v_fmac_f32 v71, v19, v111
    s_waitcnt lgkmcnt(3)
    v_pk_add_f32 v[56:57], v[56:57], v[72:73]
    v_pk_add_f32 v[58:59], v[58:59], v[74:75]
    v_cvt_pk_bf16_f32 v112, v56, v57
    v_cvt_pk_bf16_f32 v113, v58, v59
    ds_write_b64 v15, v[112:113] offset:0
    s_waitcnt lgkmcnt(3)
    v_pk_add_f32 v[60:61], v[60:61], v[76:77]
    v_pk_add_f32 v[62:63], v[62:63], v[78:79]
    v_cvt_pk_bf16_f32 v114, v60, v61
    v_cvt_pk_bf16_f32 v115, v62, v63
    ds_write_b64 v15, v[114:115] offset:2048
    s_waitcnt lgkmcnt(3)
    v_pk_add_f32 v[64:65], v[64:65], v[80:81]
    v_pk_add_f32 v[66:67], v[66:67], v[82:83]
    v_cvt_pk_bf16_f32 v116, v64, v65
    v_cvt_pk_bf16_f32 v117, v66, v67
    ds_write_b64 v15, v[116:117] offset:4096
    s_waitcnt lgkmcnt(3)
    v_pk_add_f32 v[68:69], v[68:69], v[84:85]
    v_pk_add_f32 v[70:71], v[70:71], v[86:87]
    v_cvt_pk_bf16_f32 v118, v68, v69
    v_cvt_pk_bf16_f32 v119, v70, v71
    ds_write_b64 v15, v[118:119] offset:6144
    s_waitcnt lgkmcnt(0)
    s_barrier
    ds_read_b128 v[56:59], v22
    ds_read_b128 v[60:63], v22 offset:1024
    s_waitcnt lgkmcnt(1)
    buffer_store_dwordx4 v[56:59], v23, s[28:31], s91 offen sc1
    s_waitcnt lgkmcnt(0)
    buffer_store_dwordx4 v[60:63], v23, s[28:31], s92 offen sc1
    s_barrier
    s_add_u32 m0, s16, 0
    s_nop 0
    buffer_load_dwordx4 v1, s[4:7], s32 offen lds
    buffer_load_dwordx4 v2, s[4:7], s32 offen offset:1024 lds
    buffer_load_dwordx4 v3, s[4:7], s32 offen offset:2048 lds
    buffer_load_dwordx4 v4, s[4:7], s32 offen offset:3072 lds
    s_add_u32 s34, s35, 0
    s_cmp_eq_u32 s19, 1
    s_cselect_b32 m0, 148480, s34
    s_nop 0
    buffer_load_dwordx4 v5, s[4:7], s32 offen lds
    s_add_u32 s32, s32, 589824
    s_add_u32 m0, s16, 37120
    s_nop 0
    buffer_load_dwordx4 v1, s[4:7], s32 offen lds
    buffer_load_dwordx4 v2, s[4:7], s32 offen offset:1024 lds
    buffer_load_dwordx4 v3, s[4:7], s32 offen offset:2048 lds
    buffer_load_dwordx4 v4, s[4:7], s32 offen offset:3072 lds
    s_add_u32 s34, s35, 37120
    s_cmp_eq_u32 s19, 1
    s_cselect_b32 m0, 148480, s34
    s_nop 0
    buffer_load_dwordx4 v5, s[4:7], s32 offen lds
    s_add_u32 s32, s32, 589824
    s_add_u32 m0, s16, 74240
    s_nop 0
    buffer_load_dwordx4 v1, s[4:7], s32 offen lds
    buffer_load_dwordx4 v2, s[4:7], s32 offen offset:1024 lds
    buffer_load_dwordx4 v3, s[4:7], s32 offen offset:2048 lds
    buffer_load_dwordx4 v4, s[4:7], s32 offen offset:3072 lds
    s_add_u32 s34, s35, 74240
    s_cmp_eq_u32 s19, 1
    s_cselect_b32 m0, 148480, s34
    s_nop 0
    buffer_load_dwordx4 v5, s[4:7], s32 offen lds
    s_add_u32 s32, s32, 589824
    v_lshlrev_b32 v132, 16, v224
    v_and_b32 v133, s56, v224
    v_lshlrev_b32 v134, 16, v225
    v_and_b32 v135, s56, v225
    v_lshlrev_b32 v136, 16, v226
    v_and_b32 v137, s56, v226
    v_lshlrev_b32 v138, 16, v227
    v_and_b32 v139, s56, v227
    v_lshlrev_b32 v140, 16, v228
KB_nc:
    s_cmp_lg_u32 s3, 0
    s_cbranch_scc1 KB_zw
    s_cmp_lt_u32 s2, 144
    s_cbranch_scc1 KB_zw
    v_lshlrev_b32 v12, 7, v0
    s_mov_b32 s17, 40960
    s_mov_b32 s58, 0
M_alk:
    s_mov_b64 exec, 0x3ffff
    buffer_load_dword v13, v12, s[52:55], s17 offen sc1
    s_waitcnt vmcnt(0)
    v_cmp_gt_u32 vcc, 32, v13
    s_mov_b64 exec, -1
    s_add_u32 s58, s58, 1
    s_and_b32 s59, vcc_lo, 0x3ffff
    s_cbranch_scc0 M_agk
    s_cmp_lt_u32 s58, 0x40000
    s_cbranch_scc0 M_agk
    s_sleep 4
    s_branch M_alk
M_agk:
KB_zw:
    s_barrier
    s_mov_b32 s58, 0
    v_add_u32 v15, s38, v8
    s_cmp_lt_u32 s2, 144
    s_cbranch_scc1 KB_zp
KB_zq:
    buffer_load_ushort v229, v216, s[28:31], s83 offen sc0 sc1
    s_add_u32 s58, s58, 1
    s_waitcnt vmcnt(0)
    v_cmp_eq_u32 vcc, 0xffff, v229
    s_cmp_lt_u32 s58, 0x20000
    s_cbranch_scc0 KB_zp
    s_cbranch_vccz KB_zp
    s_sleep 6
    s_branch KB_zq
KB_zp:
    buffer_load_dwordx4 v[180:183], v8, s[28:31], s82 offen sc0 sc1
    buffer_load_ushort v229, v216, s[28:31], s83 offen sc0 sc1
    s_add_u32 s58, s58, 1
    s_waitcnt vmcnt(0)
    v_max3_u32 v12, v180, v181, v182
    v_lshl_or_b32 v13, v229, 16, v229
    v_max3_u32 v12, v12, v183, v13
    v_cmp_eq_u32 vcc, -1, v12
    s_cmp_lt_u32 s58, 0x20000
    s_cbranch_scc0 KB_zg
    s_cbranch_vccz KB_zg
    s_sleep 2
    s_branch KB_zp
KB_zg:
    ds_write_b128 v15, v[180:183]
    ds_read_b64_tr_b16 v[180:181], v217
    ds_read_b64_tr_b16 v[182:183], v217 offset:64
    v_sub_f32 v144, v132, v230
    v_sub_f32 v145, v133, v230
    v_sub_f32 v146, v134, v230
    v_sub_f32 v147, v135, v230
    v_sub_f32 v148, v136, v230
    v_sub_f32 v149, v137, v230
    v_sub_f32 v150, v138, v230
    v_sub_f32 v151, v139, v230
    v_sub_f32 v152, v140, v230
    v_mul_f32 v144, v144, v231
    v_mul_f32 v145, v145, v231
    v_mul_f32 v146, v146, v231
    v_mul_f32 v147, v147, v231
    v_mul_f32 v148, v148, v231
    v_mul_f32 v149, v149, v231
    v_mul_f32 v150, v150, v231
    v_mul_f32 v151, v151, v231
    v_mul_f32 v152, v152, v231
    s_waitcnt lgkmcnt(0)
    v_lshlrev_b32 v164, 16, v180
    v_and_b32 v165, s56, v180
    v_lshlrev_b32 v166, 16, v181
    v_and_b32 v167, s56, v181
    v_lshlrev_b32 v168, 16, v182
    v_and_b32 v169, s56, v182
    v_lshlrev_b32 v170, 16, v183
    v_and_b32 v171, s56, v183
    v_lshlrev_b32 v172, 16, v229
    v_fma_f32 v144, v144, v164, v132
    v_fma_f32 v145, v145, v165, v133
    v_fma_f32 v146, v146, v166, v134
    v_fma_f32 v147, v147, v167, v135
    v_fma_f32 v148, v148, v168, v136
    v_fma_f32 v149, v149, v169, v137
    v_fma_f32 v150, v150, v170, v138
    v_fma_f32 v151, v151, v171, v139
    v_fma_f32 v152, v152, v172, v140
    v_cvt_pk_bf16_f32 v224, v144, v145
    v_cvt_pk_bf16_f32 v225, v146, v147
    v_cvt_pk_bf16_f32 v226, v148, v149
    v_cvt_pk_bf16_f32 v227, v150, v151
    v_cvt_pk_bf16_f32 v228, v152, v152
    buffer_store_dwordx4 v[224:227], v214, s[48:51], 0 offen sc1
    v_lshlrev_b32 v221, 4, v212
    v_lshl_add_u32 v221, v213, 1, v221
    s_lshl_b32 s17, s3, 8
    s_add_u32 s17, s17, 157696
    v_add_u32 v221, s17, v221
    ds_write_b16 v221, v228
    v_lshlrev_b32 v132, 16, v224
    v_and_b32 v133, s56, v224
    v_lshlrev_b32 v134, 16, v225
    v_and_b32 v135, s56, v225
    v_lshlrev_b32 v136, 16, v226
    v_and_b32 v137, s56, v226
    v_lshlrev_b32 v138, 16, v227
    v_and_b32 v139, s56, v227
    v_lshlrev_b32 v140, 16, v228
    v_add_f32 v156, v132, v133
    v_mul_f32 v157, v132, v132
    v_fmac_f32 v157, v133, v133
    v_add_f32 v156, v156, v134
    v_fmac_f32 v157, v134, v134
    v_add_f32 v156, v156, v135
    v_fmac_f32 v157, v135, v135
    v_add_f32 v156, v156, v136
    v_fmac_f32 v157, v136, v136
    v_add_f32 v156, v156, v137
    v_fmac_f32 v157, v137, v137
    v_add_f32 v156, v156, v138
    v_fmac_f32 v157, v138, v138
    v_add_f32 v156, v156, v139
    v_fmac_f32 v157, v139, v139
    v_add_f32 v156, v156, v140
    v_fmac_f32 v157, v140, v140
    s_nop 0
    v_add_f32_dpp v156, v156, v156 row_ror:8 row_mask:0xf bank_mask:0xf
    v_add_f32_dpp v157, v157, v157 row_ror:8 row_mask:0xf bank_mask:0xf
    v_mov_b32 v158, v156
    v_mov_b32 v159, v157
    s_nop 0
    v_permlane16_swap_b32 v156, v158
    v_permlane16_swap_b32 v157, v159
    v_add_f32 v156, v156, v158
    v_add_f32 v157, v157, v159
    v_mov_b32 v158, v156
    v_mov_b32 v159, v157
    s_nop 0
    v_permlane32_swap_b32 v156, v158
    v_permlane32_swap_b32 v157, v159
    v_add_f32 v156, v156, v158
    v_add_f32 v157, v157, v159
    s_mov_b64 exec, 0xff
    ds_write_b64 v219, v[156:157] offset:640
    s_mov_b64 exec, -1
    s_waitcnt lgkmcnt(0)
    s_barrier
    ds_read_b128 v[164:167], v220 offset:640
    ds_read_b128 v[168:171], v220 offset:656
    ds_read_b128 v[172:175], v220 offset:672
    ds_read_b128 v[176:179], v220 offset:688
    s_waitcnt lgkmcnt(0)
    v_pk_add_f32 v[164:165], v[164:165], v[166:167]
    v_pk_add_f32 v[168:169], v[168:169], v[170:171]
    v_pk_add_f32 v[172:173], v[172:173], v[174:175]
    v_pk_add_f32 v[176:177], v[176:177], v[178:179]
    v_pk_add_f32 v[164:165], v[164:165], v[168:169]
    v_pk_add_f32 v[172:173], v[172:173], v[176:177]
    v_pk_add_f32 v[164:165], v[164:165], v[172:173]
    v_mul_f32 v230, s57, v164
    v_mul_f32 v231, s57, v165
    v_fma_f32 v231, -v230, v230, v231
    v_max_f32 v231, 0, v231
    v_cvt_pk_bf16_f32 v158, v230, v231
    v_lshlrev_b32 v230, 16, v158
    v_and_b32 v231, s56, v158
    v_add_f32 v231, s42, v231
    v_cvt_pk_bf16_f32 v231, v231, v231
    v_and_b32 v231, s56, v231
    v_sqrt_f32 v231, v231
    s_nop 0
    v_cvt_pk_bf16_f32 v231, v231, v231
    v_and_b32 v231, s56, v231
    v_rcp_f32 v231, v231
    s_cmp_lt_u32 s2, 144
    s_cbranch_scc1 KB_ncl
    s_cmp_lg_u32 s3, 1
    s_cbranch_scc1 KB_ncl
    v_mov_b32 v12, 0
    v_mov_b32 v13, 1
    s_mov_b32 s18, 43264
    s_mov_b64 exec, 1
    buffer_atomic_add v13, v12, s[52:55], s18 offen sc1
    s_mov_b64 exec, -1
KB_ncl:
    v_sub_f32 v144, v132, v230
    v_sub_f32 v145, v133, v230
    v_sub_f32 v146, v134, v230
    v_sub_f32 v147, v135, v230
    v_sub_f32 v148, v136, v230
    v_sub_f32 v149, v137, v230
    v_sub_f32 v150, v138, v230
    v_sub_f32 v151, v139, v230
    v_sub_f32 v152, v140, v230
    v_mul_f32 v144, v144, v231
    v_mul_f32 v145, v145, v231
    v_mul_f32 v146, v146, v231
    v_mul_f32 v147, v147, v231
    v_mul_f32 v148, v148, v231
    v_mul_f32 v149, v149, v231
    v_mul_f32 v150, v150, v231
    v_mul_f32 v151, v151, v231
    v_mul_f32 v152, v152, v231
    v_cvt_pk_bf16_f32 v180, v144, v145
    v_cvt_pk_bf16_f32 v181, v146, v147
    v_cvt_pk_bf16_f32 v182, v148, v149
    v_cvt_pk_bf16_f32 v183, v150, v151
    v_cvt_pk_bf16_f32 v229, v152, v152
    ds_write_b16 v221, v229 offset:128
    buffer_store_dwordx4 v[180:183], v218, s[24:27], s37 offen sc1
    v_add_u32 v221, s17, v8
    s_waitcnt lgkmcnt(0)
    ds_read_b128 v[164:167], v221
    ds_read_b128 v[168:171], v221 offset:128
    s_lshr_b32 s17, s3, 1
    s_add_u32 s17, s17, 32
    s_lshl_b32 s17, s17, 10
    s_and_b32 s18, s3, 1
    s_lshl_b32 s18, s18, 9
    s_add_u32 s17, s17, s18
    s_add_u32 s36, s36, s17
    s_waitcnt lgkmcnt(0)
    s_mov_b64 exec, 0xff
    buffer_store_dwordx4 v[168:171], v8, s[24:27], s36 offen sc1
    buffer_store_dwordx4 v[164:167], v215, s[48:51], 0 offen sc1
    s_mov_b64 exec, -1
    s_add_u32 s28, s10, 16777216
    s_addc_u32 s29, s11, 0
    s_mov_b32 s30, 18874368
    s_mov_b32 s31, 0x00020000
    v_bfe_u32 v11, v0, 1, 1
    s_movk_i32 s17, 18560
    v_mul_u32_u24 v6, s17, v11
    v_lshrrev_b32 v11, 5, v0
    v_bfe_u32 v12, v0, 2, 2
    v_lshl_add_u32 v11, v11, 3, v12
    v_mul_u32_u24 v11, 288, v11
    v_add_u32 v6, v6, v11
    v_and_b32 v11, 1, v0
    v_lshl_add_u32 v6, v11, 4, v6
    v_bfe_u32 v11, v0, 4, 1
    v_lshl_add_u32 v6, v11, 3, v6
    v_add_u32 v7, 74240, v6
    v_bfe_u32 v11, v0, 4, 1
    s_mov_b32 s17, 147456
    v_mul_lo_u32 v9, s17, v11
    v_lshrrev_b32 v11, 5, v0
    v_lshl_add_u32 v9, v11, 8, v9
    v_and_b32 v11, 15, v0
    v_lshl_add_u32 v9, v11, 4, v9
    s_mul_i32 s37, s13, 294912
    s_mul_i32 s17, s12, 4608
    s_add_u32 s37, s37, s17
    s_lshl_b32 s17, s95, 9
    s_add_u32 s37, s37, s17
    v_mov_b32 v10, 0xbdd2d3e8
    s_lshl_b32 s39, s43, 7
    s_add_u32 s39, s39, 32768
    v_mov_b32 v12, 0
    v_mov_b32 v13, 1
    s_mov_b32 s42, s33
    s_cmp_ge_u32 s2, 144
    s_cbranch_scc1 KB_sk2
    s_add_u32 m0, s16, 111360
    s_nop 0
    buffer_load_dwordx4 v1, s[4:7], s32 offen lds
    buffer_load_dwordx4 v2, s[4:7], s32 offen offset:1024 lds
    buffer_load_dwordx4 v3, s[4:7], s32 offen offset:2048 lds
    buffer_load_dwordx4 v4, s[4:7], s32 offen offset:3072 lds
    s_add_u32 s34, s35, 111360
    s_cmp_eq_u32 s19, 1
    s_cselect_b32 m0, 148480, s34
    s_nop 0
    buffer_load_dwordx4 v5, s[4:7], s32 offen lds
    s_add_u32 s32, s32, 589824
KB_sk2:
    buffer_load_dwordx4 v[48:51], v8, s[24:27], s33 offen offset:0 sc1
    buffer_load_dwordx4 v[52:55], v8, s[24:27], s33 offen offset:1024 sc1
    buffer_load_dwordx4 v[56:59], v8, s[24:27], s33 offen offset:2048 sc1
    buffer_load_dwordx4 v[60:63], v8, s[24:27], s33 offen offset:3072 sc1
    s_add_u32 s33, s33, 4096
    s_mov_b32 s58, 0
    s_waitcnt vmcnt(0)
KB_tc0:
    v_max3_u32 v12, v48, v49, v50
    v_max3_u32 v13, v51, v52, v53
    v_max3_u32 v14, v54, v55, v56
    v_max3_u32 v12, v12, v57, v58
    v_max3_u32 v13, v13, v59, v60
    v_max3_u32 v14, v14, v61, v62
    v_max3_u32 v12, v12, v13, v63
    v_max_u32 v12, v12, v14
    v_cmp_eq_u32 vcc, -1, v12
    s_nop 1
    s_cbranch_vccnz KB_tr0
KB_tb0:
    s_barrier
    buffer_load_dwordx4 v[64:67], v8, s[24:27], s33 offen offset:0 sc1
    buffer_load_dwordx4 v[68:71], v8, s[24:27], s33 offen offset:1024 sc1
    buffer_load_dwordx4 v[72:75], v8, s[24:27], s33 offen offset:2048 sc1
    buffer_load_dwordx4 v[76:79], v8, s[24:27], s33 offen offset:3072 sc1
    s_add_u32 s33, s33, 4096
    s_mov_b32 s20, s44
    s_mov_b32 s21, s45
    s_mov_b32 s22, 5308416
    s_mov_b32 s23, 0x00020000
    s_lshl_b32 s44, s2, 3
    s_add_u32 s44, s44, s3
    s_mul_i32 s44, s44, 2592
    v_lshlrev_b32 v11, 3, v8
    ds_read_b64_tr_b16 v[24:25], v6 offset:0
    ds_read_b64_tr_b16 v[26:27], v6 offset:1152
    ds_read_b64_tr_b16 v[28:29], v6 offset:32
    ds_read_b64_tr_b16 v[30:31], v6 offset:1184
    ds_read_b64_tr_b16 v[32:33], v6 offset:64
    ds_read_b64_tr_b16 v[34:35], v6 offset:1216
    ds_read_b64_tr_b16 v[36:37], v6 offset:96
    ds_read_b64_tr_b16 v[38:39], v6 offset:1248
    ds_read_b64_tr_b16 v[40:41], v6 offset:128
    ds_read_b64_tr_b16 v[42:43], v6 offset:1280
    s_waitcnt lgkmcnt(8)
    v_mfma_f32_32x32x16_bf16 v[112:127], v[24:27], v[48:51], 0
    ds_read_b64_tr_b16 v[44:45], v6 offset:160
    ds_read_b64_tr_b16 v[46:47], v6 offset:1312
    buffer_load_dwordx4 v[80:83], v8, s[24:27], s33 offen offset:0 sc1
    s_waitcnt lgkmcnt(8)
    v_mfma_f32_32x32x16_bf16 v[128:143], v[28:31], v[48:51], 0
    ds_read_b64_tr_b16 v[24:25], v6 offset:192
    ds_read_b64_tr_b16 v[26:27], v6 offset:1344
    s_waitcnt lgkmcnt(8)
    v_mfma_f32_32x32x16_bf16 v[144:159], v[32:35], v[48:51], 0
    ds_read_b64_tr_b16 v[28:29], v6 offset:224
    ds_read_b64_tr_b16 v[30:31], v6 offset:1376
    buffer_load_dwordx4 v[84:87], v8, s[24:27], s33 offen offset:1024 sc1
    s_waitcnt lgkmcnt(8)
    v_mfma_f32_32x32x16_bf16 v[160:175], v[36:39], v[48:51], 0
    ds_read_b64_tr_b16 v[32:33], v6 offset:256
    ds_read_b64_tr_b16 v[34:35], v6 offset:1408
    s_waitcnt lgkmcnt(8)
    v_mfma_f32_32x32x16_bf16 v[176:191], v[40:43], v[48:51], 0
    ds_read_b64_tr_b16 v[36:37], v6 offset:4608
    ds_read_b64_tr_b16 v[38:39], v6 offset:5760
    buffer_load_dwordx4 v[88:91], v8, s[24:27], s33 offen offset:2048 sc1
    s_waitcnt lgkmcnt(8)
    v_mfma_f32_32x32x16_bf16 v[192:207], v[44:47], v[48:51], 0
    ds_read_b64_tr_b16 v[40:41], v6 offset:4640
    ds_read_b64_tr_b16 v[42:43], v6 offset:5792
    s_waitcnt lgkmcnt(8)
    v_mfma_f32_32x32x16_bf16 v[208:223], v[24:27], v[48:51], 0
    ds_read_b64_tr_b16 v[44:45], v6 offset:4672
    ds_read_b64_tr_b16 v[46:47], v6 offset:5824
    buffer_load_dwordx4 v[92:95], v8, s[24:27], s33 offen offset:3072 sc1
    s_add_u32 s33, s33, 4096
    s_waitcnt lgkmcnt(8)
    v_mfma_f32_32x32x16_bf16 v[224:239], v[28:31], v[48:51], 0
    ds_read_b64_tr_b16 v[24:25], v6 offset:4704
    ds_read_b64_tr_b16 v[26:27], v6 offset:5856
    s_waitcnt lgkmcnt(8)
    v_mfma_f32_32x32x16_bf16 v[240:255], v[32:35], v[48:51], 0
    ds_read_b64_tr_b16 v[28:29], v6 offset:4736
    ds_read_b64_tr_b16 v[30:31], v6 offset:5888
    buffer_load_dwordx4 v[96:99], v8, s[24:27], s33 offen offset:0 sc1
    s_waitcnt lgkmcnt(8)
    v_mfma_f32_32x32x16_bf16 v[112:127], v[36:39], v[52:55], v[112:127]
    ds_read_b64_tr_b16 v[32:33], v6 offset:4768
    ds_read_b64_tr_b16 v[34:35], v6 offset:5920
    s_waitcnt lgkmcnt(8)
    v_mfma_f32_32x32x16_bf16 v[128:143], v[40:43], v[52:55], v[128:143]
    ds_read_b64_tr_b16 v[36:37], v6 offset:4800
    ds_read_b64_tr_b16 v[38:39], v6 offset:5952
    buffer_load_dwordx4 v[100:103], v8, s[24:27], s33 offen offset:1024 sc1
    s_waitcnt lgkmcnt(8)
    v_mfma_f32_32x32x16_bf16 v[144:159], v[44:47], v[52:55], v[144:159]
    ds_read_b64_tr_b16 v[40:41], v6 offset:4832
    ds_read_b64_tr_b16 v[42:43], v6 offset:5984
    s_waitcnt lgkmcnt(8)
    v_mfma_f32_32x32x16_bf16 v[160:175], v[24:27], v[52:55], v[160:175]
    ds_read_b64_tr_b16 v[44:45], v6 offset:4864
    ds_read_b64_tr_b16 v[46:47], v6 offset:6016
    buffer_load_dwordx4 v[104:107], v8, s[24:27], s33 offen offset:2048 sc1
    s_waitcnt lgkmcnt(8)
    v_mfma_f32_32x32x16_bf16 v[176:191], v[28:31], v[52:55], v[176:191]
    ds_read_b64_tr_b16 v[24:25], v6 offset:9216
    ds_read_b64_tr_b16 v[26:27], v6 offset:10368
    s_waitcnt lgkmcnt(8)
    v_mfma_f32_32x32x16_bf16 v[192:207], v[32:35], v[52:55], v[192:207]
    ds_read_b64_tr_b16 v[28:29], v6 offset:9248
    ds_read_b64_tr_b16 v[30:31], v6 offset:10400
    buffer_load_dwordx4 v[108:111], v8, s[24:27], s33 offen offset:3072 sc1
    s_add_u32 s33, s33, 4096
    s_waitcnt lgkmcnt(8)
    v_mfma_f32_32x32x16_bf16 v[208:223], v[36:39], v[52:55], v[208:223]
    ds_read_b64_tr_b16 v[32:33], v6 offset:9280
    ds_read_b64_tr_b16 v[34:35], v6 offset:10432
    s_waitcnt lgkmcnt(8)
    v_mfma_f32_32x32x16_bf16 v[224:239], v[40:43], v[52:55], v[224:239]
    ds_read_b64_tr_b16 v[36:37], v6 offset:9312
    ds_read_b64_tr_b16 v[38:39], v6 offset:10464
    buffer_load_dwordx4 v[48:51], v8, s[24:27], s33 offen offset:0 sc1
    s_waitcnt lgkmcnt(8)
    v_mfma_f32_32x32x16_bf16 v[240:255], v[44:47], v[52:55], v[240:255]
    ds_read_b64_tr_b16 v[40:41], v6 offset:9344
    ds_read_b64_tr_b16 v[42:43], v6 offset:10496
    s_waitcnt lgkmcnt(8)
    v_mfma_f32_32x32x16_bf16 v[112:127], v[24:27], v[56:59], v[112:127]
    ds_read_b64_tr_b16 v[44:45], v6 offset:9376
    ds_read_b64_tr_b16 v[46:47], v6 offset:10528
    buffer_load_dwordx4 v[52:55], v8, s[24:27], s33 offen offset:1024 sc1
    s_waitcnt lgkmcnt(8)
    v_mfma_f32_32x32x16_bf16 v[128:143], v[28:31], v[56:59], v[128:143]
    ds_read_b64_tr_b16 v[24:25], v6 offset:9408
    ds_read_b64_tr_b16 v[26:27], v6 offset:10560
    s_waitcnt lgkmcnt(8)
    v_mfma_f32_32x32x16_bf16 v[144:159], v[32:35], v[56:59], v[144:159]
    ds_read_b64_tr_b16 v[28:29], v6 offset:9440
    ds_read_b64_tr_b16 v[30:31], v6 offset:10592
    s_waitcnt lgkmcnt(8)
    v_mfma_f32_32x32x16_bf16 v[160:175], v[36:39], v[56:59], v[160:175]
    ds_read_b64_tr_b16 v[32:33], v6 offset:9472
    ds_read_b64_tr_b16 v[34:35], v6 offset:10624
    s_waitcnt lgkmcnt(8)
    v_mfma_f32_32x32x16_bf16 v[176:191], v[40:43], v[56:59], v[176:191]
    ds_read_b64_tr_b16 v[36:37], v6 offset:13824
    ds_read_b64_tr_b16 v[38:39], v6 offset:14976
    s_waitcnt lgkmcnt(8)
    v_mfma_f32_32x32x16_bf16 v[192:207], v[44:47], v[56:59], v[192:207]
    ds_read_b64_tr_b16 v[40:41], v6 offset:13856
    ds_read_b64_tr_b16 v[42:43], v6 offset:15008
    s_waitcnt lgkmcnt(8)
    v_mfma_f32_32x32x16_bf16 v[208:223], v[24:27], v[56:59], v[208:223]
    ds_read_b64_tr_b16 v[44:45], v6 offset:13888
    ds_read_b64_tr_b16 v[46:47], v6 offset:15040
    s_waitcnt lgkmcnt(8)
    v_mfma_f32_32x32x16_bf16 v[224:239], v[28:31], v[56:59], v[224:239]
    ds_read_b64_tr_b16 v[24:25], v6 offset:13920
    ds_read_b64_tr_b16 v[26:27], v6 offset:15072
    s_waitcnt lgkmcnt(8)
    v_mfma_f32_32x32x16_bf16 v[240:255], v[32:35], v[56:59], v[240:255]
    ds_read_b64_tr_b16 v[28:29], v6 offset:13952
    ds_read_b64_tr_b16 v[30:31], v6 offset:15104
    buffer_load_dwordx4 v[56:59], v8, s[24:27], s33 offen offset:2048 sc1
    s_waitcnt lgkmcnt(8)
    v_mfma_f32_32x32x16_bf16 v[112:127], v[36:39], v[60:63], v[112:127]
    ds_read_b64_tr_b16 v[32:33], v6 offset:13984
    ds_read_b64_tr_b16 v[34:35], v6 offset:15136
    s_waitcnt lgkmcnt(8)
    v_mfma_f32_32x32x16_bf16 v[128:143], v[40:43], v[60:63], v[128:143]
    ds_read_b64_tr_b16 v[36:37], v6 offset:14016
    ds_read_b64_tr_b16 v[38:39], v6 offset:15168
    s_waitcnt lgkmcnt(8)
    v_mfma_f32_32x32x16_bf16 v[144:159], v[44:47], v[60:63], v[144:159]
    ds_read_b64_tr_b16 v[40:41], v6 offset:14048
    ds_read_b64_tr_b16 v[42:43], v6 offset:15200
    s_waitcnt lgkmcnt(8)
    v_mfma_f32_32x32x16_bf16 v[160:175], v[24:27], v[60:63], v[160:175]
    ds_read_b64_tr_b16 v[44:45], v6 offset:14080
    ds_read_b64_tr_b16 v[46:47], v6 offset:15232
    s_waitcnt lgkmcnt(8)
    v_mfma_f32_32x32x16_bf16 v[176:191], v[28:31], v[60:63], v[176:191]
    ds_read_b64_tr_b16 v[24:25], v6 offset:37120
    ds_read_b64_tr_b16 v[26:27], v6 offset:38272
    s_waitcnt lgkmcnt(8)
    v_mfma_f32_32x32x16_bf16 v[192:207], v[32:35], v[60:63], v[192:207]
    ds_read_b64_tr_b16 v[28:29], v6 offset:37152
    ds_read_b64_tr_b16 v[30:31], v6 offset:38304
    s_waitcnt lgkmcnt(8)
    v_mfma_f32_32x32x16_bf16 v[208:223], v[36:39], v[60:63], v[208:223]
    ds_read_b64_tr_b16 v[32:33], v6 offset:37184
    ds_read_b64_tr_b16 v[34:35], v6 offset:38336
    s_waitcnt lgkmcnt(8)
    v_mfma_f32_32x32x16_bf16 v[224:239], v[40:43], v[60:63], v[224:239]
    ds_read_b64_tr_b16 v[36:37], v6 offset:37216
    ds_read_b64_tr_b16 v[38:39], v6 offset:38368
    s_waitcnt lgkmcnt(8)
    v_mfma_f32_32x32x16_bf16 v[240:255], v[44:47], v[60:63], v[240:255]
    ds_read_b64_tr_b16 v[40:41], v6 offset:37248
    ds_read_b64_tr_b16 v[42:43], v6 offset:38400
    buffer_load_dwordx4 v[60:63], v8, s[24:27], s33 offen offset:3072 sc1
    s_add_u32 s33, s33, 4096
    s_waitcnt vmcnt(12)
KB_tc1:
    v_max3_u32 v12, v64, v65, v66
    v_max3_u32 v13, v67, v68, v69
    v_max3_u32 v14, v70, v71, v72
    v_max3_u32 v12, v12, v73, v74
    v_max3_u32 v13, v13, v75, v76
    v_max3_u32 v14, v14, v77, v78
    v_max3_u32 v12, v12, v13, v79
    v_max_u32 v12, v12, v14
    v_cmp_eq_u32 vcc, -1, v12
    s_nop 1
    s_cbranch_vccnz KB_tr1
KB_tb1:
    s_waitcnt lgkmcnt(8)
    v_mfma_f32_32x32x16_bf16 v[112:127], v[24:27], v[64:67], v[112:127]
    ds_read_b64_tr_b16 v[44:45], v6 offset:37280
    ds_read_b64_tr_b16 v[46:47], v6 offset:38432
    s_barrier
    s_waitcnt lgkmcnt(8)
    v_mfma_f32_32x32x16_bf16 v[128:143], v[28:31], v[64:67], v[128:143]
    ds_read_b64_tr_b16 v[24:25], v6 offset:37312
    ds_read_b64_tr_b16 v[26:27], v6 offset:38464
    s_add_u32 m0, s16, 0
    s_nop 0
    buffer_load_dwordx4 v1, s[4:7], s32 offen lds
    s_waitcnt lgkmcnt(8)
    v_mfma_f32_32x32x16_bf16 v[144:159], v[32:35], v[64:67], v[144:159]
    ds_read_b64_tr_b16 v[28:29], v6 offset:37344
    ds_read_b64_tr_b16 v[30:31], v6 offset:38496
    s_waitcnt lgkmcnt(8)
    v_mfma_f32_32x32x16_bf16 v[160:175], v[36:39], v[64:67], v[160:175]
    ds_read_b64_tr_b16 v[32:33], v6 offset:37376
    ds_read_b64_tr_b16 v[34:35], v6 offset:38528
    buffer_load_dwordx4 v2, s[4:7], s32 offen offset:1024 lds
    s_waitcnt lgkmcnt(8)
    v_mfma_f32_32x32x16_bf16 v[176:191], v[40:43], v[64:67], v[176:191]
    ds_read_b64_tr_b16 v[36:37], v6 offset:41728
    ds_read_b64_tr_b16 v[38:39], v6 offset:42880
    s_waitcnt lgkmcnt(8)
    v_mfma_f32_32x32x16_bf16 v[192:207], v[44:47], v[64:67], v[192:207]
    ds_read_b64_tr_b16 v[40:41], v6 offset:41760
    ds_read_b64_tr_b16 v[42:43], v6 offset:42912
    buffer_load_dwordx4 v3, s[4:7], s32 offen offset:2048 lds
    s_waitcnt lgkmcnt(8)
    v_mfma_f32_32x32x16_bf16 v[208:223], v[24:27], v[64:67], v[208:223]
    ds_read_b64_tr_b16 v[44:45], v6 offset:41792
    ds_read_b64_tr_b16 v[46:47], v6 offset:42944
    s_waitcnt lgkmcnt(8)
    v_mfma_f32_32x32x16_bf16 v[224:239], v[28:31], v[64:67], v[224:239]
    ds_read_b64_tr_b16 v[24:25], v6 offset:41824
    ds_read_b64_tr_b16 v[26:27], v6 offset:42976
    buffer_load_dwordx4 v4, s[4:7], s32 offen offset:3072 lds
    s_waitcnt lgkmcnt(8)
    v_mfma_f32_32x32x16_bf16 v[240:255], v[32:35], v[64:67], v[240:255]
    ds_read_b64_tr_b16 v[28:29], v6 offset:41856
    ds_read_b64_tr_b16 v[30:31], v6 offset:43008
    s_waitcnt lgkmcnt(8)
    v_mfma_f32_32x32x16_bf16 v[112:127], v[36:39], v[68:71], v[112:127]
    ds_read_b64_tr_b16 v[32:33], v6 offset:41888
    ds_read_b64_tr_b16 v[34:35], v6 offset:43040
    s_add_u32 s34, s35, 0
    s_cmp_eq_u32 s19, 1
    s_cselect_b32 m0, 148480, s34
    s_nop 0
    buffer_load_dwordx4 v5, s[4:7], s32 offen lds
    s_add_u32 s32, s32, 589824
    s_waitcnt lgkmcnt(8)
    v_mfma_f32_32x32x16_bf16 v[128:143], v[40:43], v[68:71], v[128:143]
    ds_read_b64_tr_b16 v[36:37], v6 offset:41920
    ds_read_b64_tr_b16 v[38:39], v6 offset:43072
    s_waitcnt lgkmcnt(8)
    v_mfma_f32_32x32x16_bf16 v[144:159], v[44:47], v[68:71], v[144:159]
    ds_read_b64_tr_b16 v[40:41], v6 offset:41952
    ds_read_b64_tr_b16 v[42:43], v6 offset:43104
    buffer_load_dwordx4 v[64:67], v8, s[24:27], s33 offen offset:0 sc1
    s_waitcnt lgkmcnt(8)
    v_mfma_f32_32x32x16_bf16 v[160:175], v[24:27], v[68:71], v[160:175]
    ds_read_b64_tr_b16 v[44:45], v6 offset:41984
    ds_read_b64_tr_b16 v[46:47], v6 offset:43136
    s_waitcnt lgkmcnt(8)
    v_mfma_f32_32x32x16_bf16 v[176:191], v[28:31], v[68:71], v[176:191]
    ds_read_b64_tr_b16 v[24:25], v6 offset:46336
    ds_read_b64_tr_b16 v[26:27], v6 offset:47488
    s_waitcnt lgkmcnt(8)
    v_mfma_f32_32x32x16_bf16 v[192:207], v[32:35], v[68:71], v[192:207]
    ds_read_b64_tr_b16 v[28:29], v6 offset:46368
    ds_read_b64_tr_b16 v[30:31], v6 offset:47520
    s_waitcnt lgkmcnt(8)
    v_mfma_f32_32x32x16_bf16 v[208:223], v[36:39], v[68:71], v[208:223]
    ds_read_b64_tr_b16 v[32:33], v6 offset:46400
    ds_read_b64_tr_b16 v[34:35], v6 offset:47552
    s_waitcnt lgkmcnt(8)
    v_mfma_f32_32x32x16_bf16 v[224:239], v[40:43], v[68:71], v[224:239]
    ds_read_b64_tr_b16 v[36:37], v6 offset:46432
    ds_read_b64_tr_b16 v[38:39], v6 offset:47584
    s_waitcnt lgkmcnt(8)
    v_mfma_f32_32x32x16_bf16 v[240:255], v[44:47], v[68:71], v[240:255]
    ds_read_b64_tr_b16 v[40:41], v6 offset:46464
    ds_read_b64_tr_b16 v[42:43], v6 offset:47616
    buffer_load_dwordx4 v[68:71], v8, s[24:27], s33 offen offset:1024 sc1
    s_waitcnt lgkmcnt(8)
    v_mfma_f32_32x32x16_bf16 v[112:127], v[24:27], v[72:75], v[112:127]
    ds_read_b64_tr_b16 v[44:45], v6 offset:46496
    ds_read_b64_tr_b16 v[46:47], v6 offset:47648
    s_waitcnt lgkmcnt(8)
    v_mfma_f32_32x32x16_bf16 v[128:143], v[28:31], v[72:75], v[128:143]
    ds_read_b64_tr_b16 v[24:25], v6 offset:46528
    ds_read_b64_tr_b16 v[26:27], v6 offset:47680
    s_waitcnt lgkmcnt(8)
    v_mfma_f32_32x32x16_bf16 v[144:159], v[32:35], v[72:75], v[144:159]
    ds_read_b64_tr_b16 v[28:29], v6 offset:46560
    ds_read_b64_tr_b16 v[30:31], v6 offset:47712
    s_waitcnt lgkmcnt(8)
    v_mfma_f32_32x32x16_bf16 v[160:175], v[36:39], v[72:75], v[160:175]
    ds_read_b64_tr_b16 v[32:33], v6 offset:46592
    ds_read_b64_tr_b16 v[34:35], v6 offset:47744
    s_waitcnt lgkmcnt(8)
    v_mfma_f32_32x32x16_bf16 v[176:191], v[40:43], v[72:75], v[176:191]
    ds_read_b64_tr_b16 v[36:37], v6 offset:50944
    ds_read_b64_tr_b16 v[38:39], v6 offset:52096
    s_waitcnt lgkmcnt(8)
    v_mfma_f32_32x32x16_bf16 v[192:207], v[44:47], v[72:75], v[192:207]
    ds_read_b64_tr_b16 v[40:41], v6 offset:50976
    ds_read_b64_tr_b16 v[42:43], v6 offset:52128
    s_waitcnt lgkmcnt(8)
    v_mfma_f32_32x32x16_bf16 v[208:223], v[24:27], v[72:75], v[208:223]
    ds_read_b64_tr_b16 v[44:45], v6 offset:51008
    ds_read_b64_tr_b16 v[46:47], v6 offset:52160
    s_waitcnt lgkmcnt(8)
    v_mfma_f32_32x32x16_bf16 v[224:239], v[28:31], v[72:75], v[224:239]
    ds_read_b64_tr_b16 v[24:25], v6 offset:51040
    ds_read_b64_tr_b16 v[26:27], v6 offset:52192
    s_waitcnt lgkmcnt(8)
    v_mfma_f32_32x32x16_bf16 v[240:255], v[32:35], v[72:75], v[240:255]
    ds_read_b64_tr_b16 v[28:29], v6 offset:51072
    ds_read_b64_tr_b16 v[30:31], v6 offset:52224
    buffer_load_dwordx4 v[72:75], v8, s[24:27], s33 offen offset:2048 sc1
    s_barrier
    s_waitcnt lgkmcnt(8)
    v_mfma_f32_32x32x16_bf16 v[112:127], v[36:39], v[76:79], v[112:127]
    ds_read_b64_tr_b16 v[32:33], v6 offset:51104
    ds_read_b64_tr_b16 v[34:35], v6 offset:52256
    s_waitcnt lgkmcnt(8)
    v_mfma_f32_32x32x16_bf16 v[128:143], v[40:43], v[76:79], v[128:143]
    ds_read_b64_tr_b16 v[36:37], v6 offset:51136
    ds_read_b64_tr_b16 v[38:39], v6 offset:52288
    s_waitcnt lgkmcnt(8)
    v_mfma_f32_32x32x16_bf16 v[144:159], v[44:47], v[76:79], v[144:159]
    ds_read_b64_tr_b16 v[40:41], v6 offset:51168
    ds_read_b64_tr_b16 v[42:43], v6 offset:52320
    s_waitcnt lgkmcnt(8)
    v_mfma_f32_32x32x16_bf16 v[160:175], v[24:27], v[76:79], v[160:175]
    ds_read_b64_tr_b16 v[44:45], v6 offset:51200
    ds_read_b64_tr_b16 v[46:47], v6 offset:52352
    s_waitcnt lgkmcnt(8)
    v_mfma_f32_32x32x16_bf16 v[176:191], v[28:31], v[76:79], v[176:191]
    ds_read_b64_tr_b16 v[24:25], v7 offset:0
    ds_read_b64_tr_b16 v[26:27], v7 offset:1152
    s_waitcnt lgkmcnt(8)
    v_mfma_f32_32x32x16_bf16 v[192:207], v[32:35], v[76:79], v[192:207]
    ds_read_b64_tr_b16 v[28:29], v7 offset:32
    ds_read_b64_tr_b16 v[30:31], v7 offset:1184
    s_waitcnt lgkmcnt(8)
    v_mfma_f32_32x32x16_bf16 v[208:223], v[36:39], v[76:79], v[208:223]
    ds_read_b64_tr_b16 v[32:33], v7 offset:64
    ds_read_b64_tr_b16 v[34:35], v7 offset:1216
    s_waitcnt lgkmcnt(8)
    v_mfma_f32_32x32x16_bf16 v[224:239], v[40:43], v[76:79], v[224:239]
    ds_read_b64_tr_b16 v[36:37], v7 offset:96
    ds_read_b64_tr_b16 v[38:39], v7 offset:1248
    s_waitcnt lgkmcnt(8)
    v_mfma_f32_32x32x16_bf16 v[240:255], v[44:47], v[76:79], v[240:255]
    ds_read_b64_tr_b16 v[40:41], v7 offset:128
    ds_read_b64_tr_b16 v[42:43], v7 offset:1280
    buffer_load_dwordx4 v[76:79], v8, s[24:27], s33 offen offset:3072 sc1
    s_add_u32 s33, s33, 4096
    s_waitcnt vmcnt(17)
KB_tc2:
    v_max3_u32 v12, v80, v81, v82
    v_max3_u32 v13, v83, v84, v85
    v_max3_u32 v14, v86, v87, v88
    v_max3_u32 v12, v12, v89, v90
    v_max3_u32 v13, v13, v91, v92
    v_max3_u32 v14, v14, v93, v94
    v_max3_u32 v12, v12, v13, v95
    v_max_u32 v12, v12, v14
    v_cmp_eq_u32 vcc, -1, v12
    s_nop 1
    s_cbranch_vccnz KB_tr2
KB_tb2:
    s_waitcnt lgkmcnt(8)
    v_mfma_f32_32x32x16_bf16 v[112:127], v[24:27], v[80:83], v[112:127]
    ds_read_b64_tr_b16 v[44:45], v7 offset:160
    ds_read_b64_tr_b16 v[46:47], v7 offset:1312
    s_barrier
    s_waitcnt lgkmcnt(8)
    v_mfma_f32_32x32x16_bf16 v[128:143], v[28:31], v[80:83], v[128:143]
    ds_read_b64_tr_b16 v[24:25], v7 offset:192
    ds_read_b64_tr_b16 v[26:27], v7 offset:1344
    s_waitcnt lgkmcnt(8)
    v_mfma_f32_32x32x16_bf16 v[144:159], v[32:35], v[80:83], v[144:159]
    ds_read_b64_tr_b16 v[28:29], v7 offset:224
    ds_read_b64_tr_b16 v[30:31], v7 offset:1376
    s_add_u32 m0, s16, 37120
    s_nop 0
    buffer_load_dwordx4 v1, s[4:7], s32 offen lds
    s_waitcnt lgkmcnt(8)
    v_mfma_f32_32x32x16_bf16 v[160:175], v[36:39], v[80:83], v[160:175]
    ds_read_b64_tr_b16 v[32:33], v7 offset:256
    ds_read_b64_tr_b16 v[34:35], v7 offset:1408
    s_waitcnt lgkmcnt(8)
    v_mfma_f32_32x32x16_bf16 v[176:191], v[40:43], v[80:83], v[176:191]
    ds_read_b64_tr_b16 v[36:37], v7 offset:4608
    ds_read_b64_tr_b16 v[38:39], v7 offset:5760
    s_waitcnt lgkmcnt(8)
    v_mfma_f32_32x32x16_bf16 v[192:207], v[44:47], v[80:83], v[192:207]
    ds_read_b64_tr_b16 v[40:41], v7 offset:4640
    ds_read_b64_tr_b16 v[42:43], v7 offset:5792
    buffer_load_dwordx4 v2, s[4:7], s32 offen offset:1024 lds
    s_waitcnt lgkmcnt(8)
    v_mfma_f32_32x32x16_bf16 v[208:223], v[24:27], v[80:83], v[208:223]
    ds_read_b64_tr_b16 v[44:45], v7 offset:4672
    ds_read_b64_tr_b16 v[46:47], v7 offset:5824
    s_waitcnt lgkmcnt(8)
    v_mfma_f32_32x32x16_bf16 v[224:239], v[28:31], v[80:83], v[224:239]
    ds_read_b64_tr_b16 v[24:25], v7 offset:4704
    ds_read_b64_tr_b16 v[26:27], v7 offset:5856
    s_waitcnt lgkmcnt(8)
    v_mfma_f32_32x32x16_bf16 v[240:255], v[32:35], v[80:83], v[240:255]
    ds_read_b64_tr_b16 v[28:29], v7 offset:4736
    ds_read_b64_tr_b16 v[30:31], v7 offset:5888
    buffer_load_dwordx4 v3, s[4:7], s32 offen offset:2048 lds
    s_waitcnt lgkmcnt(8)
    v_mfma_f32_32x32x16_bf16 v[112:127], v[36:39], v[84:87], v[112:127]
    ds_read_b64_tr_b16 v[32:33], v7 offset:4768
    ds_read_b64_tr_b16 v[34:35], v7 offset:5920
    s_waitcnt lgkmcnt(8)
    v_mfma_f32_32x32x16_bf16 v[128:143], v[40:43], v[84:87], v[128:143]
    ds_read_b64_tr_b16 v[36:37], v7 offset:4800
    ds_read_b64_tr_b16 v[38:39], v7 offset:5952
    s_waitcnt lgkmcnt(8)
    v_mfma_f32_32x32x16_bf16 v[144:159], v[44:47], v[84:87], v[144:159]
    ds_read_b64_tr_b16 v[40:41], v7 offset:4832
    ds_read_b64_tr_b16 v[42:43], v7 offset:5984
    buffer_load_dwordx4 v4, s[4:7], s32 offen offset:3072 lds
    s_waitcnt lgkmcnt(8)
    v_mfma_f32_32x32x16_bf16 v[160:175], v[24:27], v[84:87], v[160:175]
    ds_read_b64_tr_b16 v[44:45], v7 offset:4864
    ds_read_b64_tr_b16 v[46:47], v7 offset:6016
    s_waitcnt lgkmcnt(8)
    v_mfma_f32_32x32x16_bf16 v[176:191], v[28:31], v[84:87], v[176:191]
    ds_read_b64_tr_b16 v[24:25], v7 offset:9216
    ds_read_b64_tr_b16 v[26:27], v7 offset:10368
    s_waitcnt lgkmcnt(8)
    v_mfma_f32_32x32x16_bf16 v[192:207], v[32:35], v[84:87], v[192:207]
    ds_read_b64_tr_b16 v[28:29], v7 offset:9248
    ds_read_b64_tr_b16 v[30:31], v7 offset:10400
    s_add_u32 s34, s35, 37120
    s_cmp_eq_u32 s19, 1
    s_cselect_b32 m0, 148480, s34
    s_nop 0
    buffer_load_dwordx4 v5, s[4:7], s32 offen lds
    s_add_u32 s32, s32, 589824
    s_waitcnt lgkmcnt(8)
    v_mfma_f32_32x32x16_bf16 v[208:223], v[36:39], v[84:87], v[208:223]
    ds_read_b64_tr_b16 v[32:33], v7 offset:9280
    ds_read_b64_tr_b16 v[34:35], v7 offset:10432
    s_waitcnt lgkmcnt(8)
    v_mfma_f32_32x32x16_bf16 v[224:239], v[40:43], v[84:87], v[224:239]
    ds_read_b64_tr_b16 v[36:37], v7 offset:9312
    ds_read_b64_tr_b16 v[38:39], v7 offset:10464
    s_waitcnt lgkmcnt(8)
    v_mfma_f32_32x32x16_bf16 v[240:255], v[44:47], v[84:87], v[240:255]
    ds_read_b64_tr_b16 v[40:41], v7 offset:9344
    ds_read_b64_tr_b16 v[42:43], v7 offset:10496
    buffer_load_dwordx4 v[80:83], v8, s[24:27], s33 offen offset:0 sc1
    s_waitcnt lgkmcnt(8)
    v_mfma_f32_32x32x16_bf16 v[112:127], v[24:27], v[88:91], v[112:127]
    ds_read_b64_tr_b16 v[44:45], v7 offset:9376
    ds_read_b64_tr_b16 v[46:47], v7 offset:10528
    s_waitcnt lgkmcnt(8)
    v_mfma_f32_32x32x16_bf16 v[128:143], v[28:31], v[88:91], v[128:143]
    ds_read_b64_tr_b16 v[24:25], v7 offset:9408
    ds_read_b64_tr_b16 v[26:27], v7 offset:10560
    s_waitcnt lgkmcnt(8)
    v_mfma_f32_32x32x16_bf16 v[144:159], v[32:35], v[88:91], v[144:159]
    ds_read_b64_tr_b16 v[28:29], v7 offset:9440
    ds_read_b64_tr_b16 v[30:31], v7 offset:10592
    buffer_load_dwordx4 v[84:87], v8, s[24:27], s33 offen offset:1024 sc1
    s_waitcnt lgkmcnt(8)
    v_mfma_f32_32x32x16_bf16 v[160:175], v[36:39], v[88:91], v[160:175]
    ds_read_b64_tr_b16 v[32:33], v7 offset:9472
    ds_read_b64_tr_b16 v[34:35], v7 offset:10624
    s_waitcnt lgkmcnt(8)
    v_mfma_f32_32x32x16_bf16 v[176:191], v[40:43], v[88:91], v[176:191]
    ds_read_b64_tr_b16 v[36:37], v7 offset:13824
    ds_read_b64_tr_b16 v[38:39], v7 offset:14976
    s_waitcnt lgkmcnt(8)
    v_mfma_f32_32x32x16_bf16 v[192:207], v[44:47], v[88:91], v[192:207]
    ds_read_b64_tr_b16 v[40:41], v7 offset:13856
    ds_read_b64_tr_b16 v[42:43], v7 offset:15008
    s_waitcnt lgkmcnt(8)
    v_mfma_f32_32x32x16_bf16 v[208:223], v[24:27], v[88:91], v[208:223]
    ds_read_b64_tr_b16 v[44:45], v7 offset:13888
    ds_read_b64_tr_b16 v[46:47], v7 offset:15040
    s_waitcnt lgkmcnt(8)
    v_mfma_f32_32x32x16_bf16 v[224:239], v[28:31], v[88:91], v[224:239]
    ds_read_b64_tr_b16 v[24:25], v7 offset:13920
    ds_read_b64_tr_b16 v[26:27], v7 offset:15072
    s_waitcnt lgkmcnt(8)
    v_mfma_f32_32x32x16_bf16 v[240:255], v[32:35], v[88:91], v[240:255]
    ds_read_b64_tr_b16 v[28:29], v7 offset:13952
    ds_read_b64_tr_b16 v[30:31], v7 offset:15104
    buffer_load_dwordx4 v[88:91], v8, s[24:27], s33 offen offset:2048 sc1
    s_waitcnt lgkmcnt(8)
    v_mfma_f32_32x32x16_bf16 v[112:127], v[36:39], v[92:95], v[112:127]
    ds_read_b64_tr_b16 v[32:33], v7 offset:13984
    ds_read_b64_tr_b16 v[34:35], v7 offset:15136
    s_waitcnt lgkmcnt(8)
    v_mfma_f32_32x32x16_bf16 v[128:143], v[40:43], v[92:95], v[128:143]
    ds_read_b64_tr_b16 v[36:37], v7 offset:14016
    ds_read_b64_tr_b16 v[38:39], v7 offset:15168
    s_waitcnt lgkmcnt(8)
    v_mfma_f32_32x32x16_bf16 v[144:159], v[44:47], v[92:95], v[144:159]
    ds_read_b64_tr_b16 v[40:41], v7 offset:14048
    ds_read_b64_tr_b16 v[42:43], v7 offset:15200
    s_waitcnt lgkmcnt(8)
    v_mfma_f32_32x32x16_bf16 v[160:175], v[24:27], v[92:95], v[160:175]
    ds_read_b64_tr_b16 v[44:45], v7 offset:14080
    ds_read_b64_tr_b16 v[46:47], v7 offset:15232
    s_waitcnt lgkmcnt(8)
    v_mfma_f32_32x32x16_bf16 v[176:191], v[28:31], v[92:95], v[176:191]
    ds_read_b64_tr_b16 v[24:25], v7 offset:37120
    ds_read_b64_tr_b16 v[26:27], v7 offset:38272
    s_waitcnt lgkmcnt(8)
    v_mfma_f32_32x32x16_bf16 v[192:207], v[32:35], v[92:95], v[192:207]
    ds_read_b64_tr_b16 v[28:29], v7 offset:37152
    ds_read_b64_tr_b16 v[30:31], v7 offset:38304
    s_waitcnt lgkmcnt(8)
    v_mfma_f32_32x32x16_bf16 v[208:223], v[36:39], v[92:95], v[208:223]
    ds_read_b64_tr_b16 v[32:33], v7 offset:37184
    ds_read_b64_tr_b16 v[34:35], v7 offset:38336
    s_waitcnt lgkmcnt(8)
    v_mfma_f32_32x32x16_bf16 v[224:239], v[40:43], v[92:95], v[224:239]
    ds_read_b64_tr_b16 v[36:37], v7 offset:37216
    ds_read_b64_tr_b16 v[38:39], v7 offset:38368
    s_waitcnt lgkmcnt(8)
    v_mfma_f32_32x32x16_bf16 v[240:255], v[44:47], v[92:95], v[240:255]
    ds_read_b64_tr_b16 v[40:41], v7 offset:37248
    ds_read_b64_tr_b16 v[42:43], v7 offset:38400
    buffer_load_dwordx4 v[92:95], v8, s[24:27], s33 offen offset:3072 sc1
    s_add_u32 s33, s33, 4096
    s_waitcnt vmcnt(22)
KB_tc3:
    v_max3_u32 v12, v96, v97, v98
    v_max3_u32 v13, v99, v100, v101
    v_max3_u32 v14, v102, v103, v104
    v_max3_u32 v12, v12, v105, v106
    v_max3_u32 v13, v13, v107, v108
    v_max3_u32 v14, v14, v109, v110
    v_max3_u32 v12, v12, v13, v111
    v_max_u32 v12, v12, v14
    v_cmp_eq_u32 vcc, -1, v12
    s_nop 1
    s_cbranch_vccnz KB_tr3
KB_tb3:
    s_waitcnt lgkmcnt(8)
    v_mfma_f32_32x32x16_bf16 v[112:127], v[24:27], v[96:99], v[112:127]
    ds_read_b64_tr_b16 v[44:45], v7 offset:37280
    ds_read_b64_tr_b16 v[46:47], v7 offset:38432
    s_waitcnt vmcnt(13)
    s_barrier
    s_waitcnt lgkmcnt(8)
    v_mfma_f32_32x32x16_bf16 v[128:143], v[28:31], v[96:99], v[128:143]
    ds_read_b64_tr_b16 v[24:25], v7 offset:37312
    ds_read_b64_tr_b16 v[26:27], v7 offset:38464
    s_waitcnt lgkmcnt(8)
    v_mfma_f32_32x32x16_bf16 v[144:159], v[32:35], v[96:99], v[144:159]
    ds_read_b64_tr_b16 v[28:29], v7 offset:37344
    ds_read_b64_tr_b16 v[30:31], v7 offset:38496
    s_add_u32 m0, s16, 74240
    s_nop 0
    buffer_load_dwordx4 v1, s[4:7], s32 offen lds
    s_waitcnt lgkmcnt(8)
    v_mfma_f32_32x32x16_bf16 v[160:175], v[36:39], v[96:99], v[160:175]
    ds_read_b64_tr_b16 v[32:33], v7 offset:37376
    ds_read_b64_tr_b16 v[34:35], v7 offset:38528
    s_waitcnt lgkmcnt(8)
    v_mfma_f32_32x32x16_bf16 v[176:191], v[40:43], v[96:99], v[176:191]
    ds_read_b64_tr_b16 v[36:37], v7 offset:41728
    ds_read_b64_tr_b16 v[38:39], v7 offset:42880
    s_waitcnt lgkmcnt(8)
    v_mfma_f32_32x32x16_bf16 v[192:207], v[44:47], v[96:99], v[192:207]
    ds_read_b64_tr_b16 v[40:41], v7 offset:41760
    ds_read_b64_tr_b16 v[42:43], v7 offset:42912
    buffer_load_dwordx4 v2, s[4:7], s32 offen offset:1024 lds
    s_waitcnt lgkmcnt(8)
    v_mfma_f32_32x32x16_bf16 v[208:223], v[24:27], v[96:99], v[208:223]
    ds_read_b64_tr_b16 v[44:45], v7 offset:41792
    ds_read_b64_tr_b16 v[46:47], v7 offset:42944
    s_waitcnt lgkmcnt(8)
    v_mfma_f32_32x32x16_bf16 v[224:239], v[28:31], v[96:99], v[224:239]
    ds_read_b64_tr_b16 v[24:25], v7 offset:41824
    ds_read_b64_tr_b16 v[26:27], v7 offset:42976
    s_waitcnt lgkmcnt(8)
    v_mfma_f32_32x32x16_bf16 v[240:255], v[32:35], v[96:99], v[240:255]
    ds_read_b64_tr_b16 v[28:29], v7 offset:41856
    ds_read_b64_tr_b16 v[30:31], v7 offset:43008
    buffer_load_dwordx4 v3, s[4:7], s32 offen offset:2048 lds
    s_waitcnt lgkmcnt(8)
    v_mfma_f32_32x32x16_bf16 v[112:127], v[36:39], v[100:103], v[112:127]
    ds_read_b64_tr_b16 v[32:33], v7 offset:41888
    ds_read_b64_tr_b16 v[34:35], v7 offset:43040
    s_waitcnt lgkmcnt(8)
    v_mfma_f32_32x32x16_bf16 v[128:143], v[40:43], v[100:103], v[128:143]
    ds_read_b64_tr_b16 v[36:37], v7 offset:41920
    ds_read_b64_tr_b16 v[38:39], v7 offset:43072
    s_waitcnt lgkmcnt(8)
    v_mfma_f32_32x32x16_bf16 v[144:159], v[44:47], v[100:103], v[144:159]
    ds_read_b64_tr_b16 v[40:41], v7 offset:41952
    ds_read_b64_tr_b16 v[42:43], v7 offset:43104
    buffer_load_dwordx4 v4, s[4:7], s32 offen offset:3072 lds
    s_waitcnt lgkmcnt(8)
    v_mfma_f32_32x32x16_bf16 v[160:175], v[24:27], v[100:103], v[160:175]
    ds_read_b64_tr_b16 v[44:45], v7 offset:41984
    ds_read_b64_tr_b16 v[46:47], v7 offset:43136
    s_waitcnt lgkmcnt(8)
    v_mfma_f32_32x32x16_bf16 v[176:191], v[28:31], v[100:103], v[176:191]
    ds_read_b64_tr_b16 v[24:25], v7 offset:46336
    ds_read_b64_tr_b16 v[26:27], v7 offset:47488
    s_waitcnt lgkmcnt(8)
    v_mfma_f32_32x32x16_bf16 v[192:207], v[32:35], v[100:103], v[192:207]
    ds_read_b64_tr_b16 v[28:29], v7 offset:46368
    ds_read_b64_tr_b16 v[30:31], v7 offset:47520
    s_add_u32 s34, s35, 74240
    s_cmp_eq_u32 s19, 1
    s_cselect_b32 m0, 148480, s34
    s_nop 0
    buffer_load_dwordx4 v5, s[4:7], s32 offen lds
    s_add_u32 s32, s32, 589824
    s_waitcnt lgkmcnt(8)
    v_mfma_f32_32x32x16_bf16 v[208:223], v[36:39], v[100:103], v[208:223]
    ds_read_b64_tr_b16 v[32:33], v7 offset:46400
    ds_read_b64_tr_b16 v[34:35], v7 offset:47552
    s_waitcnt lgkmcnt(8)
    v_mfma_f32_32x32x16_bf16 v[224:239], v[40:43], v[100:103], v[224:239]
    ds_read_b64_tr_b16 v[36:37], v7 offset:46432
    ds_read_b64_tr_b16 v[38:39], v7 offset:47584
    s_waitcnt lgkmcnt(8)
    v_mfma_f32_32x32x16_bf16 v[240:255], v[44:47], v[100:103], v[240:255]
    ds_read_b64_tr_b16 v[40:41], v7 offset:46464
    ds_read_b64_tr_b16 v[42:43], v7 offset:47616
    buffer_load_dwordx4 v[96:99], v8, s[24:27], s33 offen offset:0 sc1
    s_waitcnt lgkmcnt(8)
    v_mfma_f32_32x32x16_bf16 v[112:127], v[24:27], v[104:107], v[112:127]
    ds_read_b64_tr_b16 v[44:45], v7 offset:46496
    ds_read_b64_tr_b16 v[46:47], v7 offset:47648
    s_waitcnt lgkmcnt(8)
    v_mfma_f32_32x32x16_bf16 v[128:143], v[28:31], v[104:107], v[128:143]
    ds_read_b64_tr_b16 v[24:25], v7 offset:46528
    ds_read_b64_tr_b16 v[26:27], v7 offset:47680
    s_waitcnt lgkmcnt(8)
    v_mfma_f32_32x32x16_bf16 v[144:159], v[32:35], v[104:107], v[144:159]
    ds_read_b64_tr_b16 v[28:29], v7 offset:46560
    ds_read_b64_tr_b16 v[30:31], v7 offset:47712
    buffer_load_dwordx4 v[100:103], v8, s[24:27], s33 offen offset:1024 sc1
    s_waitcnt lgkmcnt(8)
    v_mfma_f32_32x32x16_bf16 v[160:175], v[36:39], v[104:107], v[160:175]
    ds_read_b64_tr_b16 v[32:33], v7 offset:46592
    ds_read_b64_tr_b16 v[34:35], v7 offset:47744
    s_waitcnt lgkmcnt(8)
    v_mfma_f32_32x32x16_bf16 v[176:191], v[40:43], v[104:107], v[176:191]
    ds_read_b64_tr_b16 v[36:37], v7 offset:50944
    ds_read_b64_tr_b16 v[38:39], v7 offset:52096
    s_waitcnt lgkmcnt(8)
    v_mfma_f32_32x32x16_bf16 v[192:207], v[44:47], v[104:107], v[192:207]
    ds_read_b64_tr_b16 v[40:41], v7 offset:50976
    ds_read_b64_tr_b16 v[42:43], v7 offset:52128
    s_waitcnt lgkmcnt(8)
    v_mfma_f32_32x32x16_bf16 v[208:223], v[24:27], v[104:107], v[208:223]
    ds_read_b64_tr_b16 v[44:45], v7 offset:51008
    ds_read_b64_tr_b16 v[46:47], v7 offset:52160
    s_waitcnt lgkmcnt(8)
    v_mfma_f32_32x32x16_bf16 v[224:239], v[28:31], v[104:107], v[224:239]
    ds_read_b64_tr_b16 v[24:25], v7 offset:51040
    ds_read_b64_tr_b16 v[26:27], v7 offset:52192
    s_waitcnt lgkmcnt(8)
    v_mfma_f32_32x32x16_bf16 v[240:255], v[32:35], v[104:107], v[240:255]
    ds_read_b64_tr_b16 v[28:29], v7 offset:51072
    ds_read_b64_tr_b16 v[30:31], v7 offset:52224
    buffer_load_dwordx4 v[104:107], v8, s[24:27], s33 offen offset:2048 sc1
    s_waitcnt lgkmcnt(8)
    v_mfma_f32_32x32x16_bf16 v[112:127], v[36:39], v[108:111], v[112:127]
    ds_read_b64_tr_b16 v[32:33], v7 offset:51104
    ds_read_b64_tr_b16 v[34:35], v7 offset:52256
    s_waitcnt lgkmcnt(8)
    v_mfma_f32_32x32x16_bf16 v[128:143], v[40:43], v[108:111], v[128:143]
    ds_read_b64_tr_b16 v[36:37], v7 offset:51136
    ds_read_b64_tr_b16 v[38:39], v7 offset:52288
    s_waitcnt lgkmcnt(8)
    v_mfma_f32_32x32x16_bf16 v[144:159], v[44:47], v[108:111], v[144:159]
    ds_read_b64_tr_b16 v[40:41], v7 offset:51168
    ds_read_b64_tr_b16 v[42:43], v7 offset:52320
    s_waitcnt lgkmcnt(8)
    v_mfma_f32_32x32x16_bf16 v[160:175], v[24:27], v[108:111], v[160:175]
    ds_read_b64_tr_b16 v[44:45], v7 offset:51200
    ds_read_b64_tr_b16 v[46:47], v7 offset:52352
    s_waitcnt lgkmcnt(8)
    v_mfma_f32_32x32x16_bf16 v[176:191], v[28:31], v[108:111], v[176:191]
    ds_read_b64_tr_b16 v[24:25], v6 offset:0
    ds_read_b64_tr_b16 v[26:27], v6 offset:1152
    s_waitcnt lgkmcnt(8)
    v_mfma_f32_32x32x16_bf16 v[192:207], v[32:35], v[108:111], v[192:207]
    ds_read_b64_tr_b16 v[28:29], v6 offset:32
    ds_read_b64_tr_b16 v[30:31], v6 offset:1184
    s_waitcnt lgkmcnt(8)
    v_mfma_f32_32x32x16_bf16 v[208:223], v[36:39], v[108:111], v[208:223]
    ds_read_b64_tr_b16 v[32:33], v6 offset:64
    ds_read_b64_tr_b16 v[34:35], v6 offset:1216
    s_waitcnt lgkmcnt(8)
    v_mfma_f32_32x32x16_bf16 v[224:239], v[40:43], v[108:111], v[224:239]
    ds_read_b64_tr_b16 v[36:37], v6 offset:96
    ds_read_b64_tr_b16 v[38:39], v6 offset:1248
    s_waitcnt lgkmcnt(8)
    v_mfma_f32_32x32x16_bf16 v[240:255], v[44:47], v[108:111], v[240:255]
    ds_read_b64_tr_b16 v[40:41], v6 offset:128
    ds_read_b64_tr_b16 v[42:43], v6 offset:1280
    buffer_load_dwordx4 v[108:111], v8, s[24:27], s33 offen offset:3072 sc1
    s_add_u32 s33, s33, 4096
KB_tc4:
    v_max3_u32 v12, v48, v49, v50
    v_max3_u32 v13, v51, v52, v53
    v_max3_u32 v14, v54, v55, v56
    v_max3_u32 v12, v12, v57, v58
    v_max3_u32 v13, v13, v59, v60
    v_max3_u32 v14, v14, v61, v62
    v_max3_u32 v12, v12, v13, v63
    v_max_u32 v12, v12, v14
    v_cmp_eq_u32 vcc, -1, v12
    s_nop 1
    s_cbranch_vccnz KB_tr4
KB_tb4:
    s_waitcnt lgkmcnt(8)
    v_mfma_f32_32x32x16_bf16 v[112:127], v[24:27], v[48:51], v[112:127]
    ds_read_b64_tr_b16 v[44:45], v6 offset:160
    ds_read_b64_tr_b16 v[46:47], v6 offset:1312
    s_waitcnt vmcnt(13)
    s_barrier
    s_waitcnt lgkmcnt(8)
    v_mfma_f32_32x32x16_bf16 v[128:143], v[28:31], v[48:51], v[128:143]
    ds_read_b64_tr_b16 v[24:25], v6 offset:192
    ds_read_b64_tr_b16 v[26:27], v6 offset:1344
    s_waitcnt lgkmcnt(8)
    v_mfma_f32_32x32x16_bf16 v[144:159], v[32:35], v[48:51], v[144:159]
    ds_read_b64_tr_b16 v[28:29], v6 offset:224
    ds_read_b64_tr_b16 v[30:31], v6 offset:1376
    s_add_u32 m0, s16, 111360
    s_nop 0
    buffer_load_dwordx4 v1, s[4:7], s32 offen lds
    s_waitcnt lgkmcnt(8)
    v_mfma_f32_32x32x16_bf16 v[160:175], v[36:39], v[48:51], v[160:175]
    ds_read_b64_tr_b16 v[32:33], v6 offset:256
    ds_read_b64_tr_b16 v[34:35], v6 offset:1408
    s_waitcnt lgkmcnt(8)
    v_mfma_f32_32x32x16_bf16 v[176:191], v[40:43], v[48:51], v[176:191]
    ds_read_b64_tr_b16 v[36:37], v6 offset:4608
    ds_read_b64_tr_b16 v[38:39], v6 offset:5760
    s_waitcnt lgkmcnt(8)
    v_mfma_f32_32x32x16_bf16 v[192:207], v[44:47], v[48:51], v[192:207]
    ds_read_b64_tr_b16 v[40:41], v6 offset:4640
    ds_read_b64_tr_b16 v[42:43], v6 offset:5792
    buffer_load_dwordx4 v2, s[4:7], s32 offen offset:1024 lds
    s_waitcnt lgkmcnt(8)
    v_mfma_f32_32x32x16_bf16 v[208:223], v[24:27], v[48:51], v[208:223]
    ds_read_b64_tr_b16 v[44:45], v6 offset:4672
    ds_read_b64_tr_b16 v[46:47], v6 offset:5824
    s_waitcnt lgkmcnt(8)
    v_mfma_f32_32x32x16_bf16 v[224:239], v[28:31], v[48:51], v[224:239]
    ds_read_b64_tr_b16 v[24:25], v6 offset:4704
    ds_read_b64_tr_b16 v[26:27], v6 offset:5856
    s_waitcnt lgkmcnt(8)
    v_mfma_f32_32x32x16_bf16 v[240:255], v[32:35], v[48:51], v[240:255]
    ds_read_b64_tr_b16 v[28:29], v6 offset:4736
    ds_read_b64_tr_b16 v[30:31], v6 offset:5888
    buffer_load_dwordx4 v3, s[4:7], s32 offen offset:2048 lds
    s_waitcnt lgkmcnt(8)
    v_mfma_f32_32x32x16_bf16 v[112:127], v[36:39], v[52:55], v[112:127]
    ds_read_b64_tr_b16 v[32:33], v6 offset:4768
    ds_read_b64_tr_b16 v[34:35], v6 offset:5920
    s_waitcnt lgkmcnt(8)
    v_mfma_f32_32x32x16_bf16 v[128:143], v[40:43], v[52:55], v[128:143]
    ds_read_b64_tr_b16 v[36:37], v6 offset:4800
    ds_read_b64_tr_b16 v[38:39], v6 offset:5952
    s_waitcnt lgkmcnt(8)
    v_mfma_f32_32x32x16_bf16 v[144:159], v[44:47], v[52:55], v[144:159]
    ds_read_b64_tr_b16 v[40:41], v6 offset:4832
    ds_read_b64_tr_b16 v[42:43], v6 offset:5984
    buffer_load_dwordx4 v4, s[4:7], s32 offen offset:3072 lds
    s_waitcnt lgkmcnt(8)
    v_mfma_f32_32x32x16_bf16 v[160:175], v[24:27], v[52:55], v[160:175]
    ds_read_b64_tr_b16 v[44:45], v6 offset:4864
    ds_read_b64_tr_b16 v[46:47], v6 offset:6016
    s_waitcnt lgkmcnt(8)
    v_mfma_f32_32x32x16_bf16 v[176:191], v[28:31], v[52:55], v[176:191]
    ds_read_b64_tr_b16 v[24:25], v6 offset:9216
    ds_read_b64_tr_b16 v[26:27], v6 offset:10368
    s_waitcnt lgkmcnt(8)
    v_mfma_f32_32x32x16_bf16 v[192:207], v[32:35], v[52:55], v[192:207]
    ds_read_b64_tr_b16 v[28:29], v6 offset:9248
    ds_read_b64_tr_b16 v[30:31], v6 offset:10400
    s_add_u32 s34, s35, 111360
    s_cmp_eq_u32 s19, 1
    s_cselect_b32 m0, 148480, s34
    s_nop 0
    buffer_load_dwordx4 v5, s[4:7], s32 offen lds
    s_add_u32 s32, s32, 589824
    s_waitcnt lgkmcnt(8)
    v_mfma_f32_32x32x16_bf16 v[208:223], v[36:39], v[52:55], v[208:223]
    ds_read_b64_tr_b16 v[32:33], v6 offset:9280
    ds_read_b64_tr_b16 v[34:35], v6 offset:10432
    s_waitcnt lgkmcnt(8)
    v_mfma_f32_32x32x16_bf16 v[224:239], v[40:43], v[52:55], v[224:239]
    ds_read_b64_tr_b16 v[36:37], v6 offset:9312
    ds_read_b64_tr_b16 v[38:39], v6 offset:10464
    s_waitcnt lgkmcnt(8)
    v_mfma_f32_32x32x16_bf16 v[240:255], v[44:47], v[52:55], v[240:255]
    ds_read_b64_tr_b16 v[40:41], v6 offset:9344
    ds_read_b64_tr_b16 v[42:43], v6 offset:10496
    buffer_load_dwordx4 v[48:51], v8, s[24:27], s33 offen offset:0 sc1
    s_waitcnt lgkmcnt(8)
    v_mfma_f32_32x32x16_bf16 v[112:127], v[24:27], v[56:59], v[112:127]
    ds_read_b64_tr_b16 v[44:45], v6 offset:9376
    ds_read_b64_tr_b16 v[46:47], v6 offset:10528
    s_waitcnt lgkmcnt(8)
    v_mfma_f32_32x32x16_bf16 v[128:143], v[28:31], v[56:59], v[128:143]
    ds_read_b64_tr_b16 v[24:25], v6 offset:9408
    ds_read_b64_tr_b16 v[26:27], v6 offset:10560
    s_waitcnt lgkmcnt(8)
    v_mfma_f32_32x32x16_bf16 v[144:159], v[32:35], v[56:59], v[144:159]
    ds_read_b64_tr_b16 v[28:29], v6 offset:9440
    ds_read_b64_tr_b16 v[30:31], v6 offset:10592
    buffer_load_dwordx4 v[52:55], v8, s[24:27], s33 offen offset:1024 sc1
    s_waitcnt lgkmcnt(8)
    v_mfma_f32_32x32x16_bf16 v[160:175], v[36:39], v[56:59], v[160:175]
    ds_read_b64_tr_b16 v[32:33], v6 offset:9472
    ds_read_b64_tr_b16 v[34:35], v6 offset:10624
    s_waitcnt lgkmcnt(8)
    v_mfma_f32_32x32x16_bf16 v[176:191], v[40:43], v[56:59], v[176:191]
    ds_read_b64_tr_b16 v[36:37], v6 offset:13824
    ds_read_b64_tr_b16 v[38:39], v6 offset:14976
    s_waitcnt lgkmcnt(8)
    v_mfma_f32_32x32x16_bf16 v[192:207], v[44:47], v[56:59], v[192:207]
    ds_read_b64_tr_b16 v[40:41], v6 offset:13856
    ds_read_b64_tr_b16 v[42:43], v6 offset:15008
    s_waitcnt lgkmcnt(8)
    v_mfma_f32_32x32x16_bf16 v[208:223], v[24:27], v[56:59], v[208:223]
    ds_read_b64_tr_b16 v[44:45], v6 offset:13888
    ds_read_b64_tr_b16 v[46:47], v6 offset:15040
    s_waitcnt lgkmcnt(8)
    v_mfma_f32_32x32x16_bf16 v[224:239], v[28:31], v[56:59], v[224:239]
    ds_read_b64_tr_b16 v[24:25], v6 offset:13920
    ds_read_b64_tr_b16 v[26:27], v6 offset:15072
    s_waitcnt lgkmcnt(8)
    v_mfma_f32_32x32x16_bf16 v[240:255], v[32:35], v[56:59], v[240:255]
    ds_read_b64_tr_b16 v[28:29], v6 offset:13952
    ds_read_b64_tr_b16 v[30:31], v6 offset:15104
    buffer_load_dwordx4 v[56:59], v8, s[24:27], s33 offen offset:2048 sc1
    s_waitcnt lgkmcnt(8)
    v_mfma_f32_32x32x16_bf16 v[112:127], v[36:39], v[60:63], v[112:127]
    ds_read_b64_tr_b16 v[32:33], v6 offset:13984
    ds_read_b64_tr_b16 v[34:35], v6 offset:15136
    s_waitcnt lgkmcnt(8)
    v_mfma_f32_32x32x16_bf16 v[128:143], v[40:43], v[60:63], v[128:143]
    ds_read_b64_tr_b16 v[36:37], v6 offset:14016
    ds_read_b64_tr_b16 v[38:39], v6 offset:15168
    s_waitcnt lgkmcnt(8)
    v_mfma_f32_32x32x16_bf16 v[144:159], v[44:47], v[60:63], v[144:159]
    ds_read_b64_tr_b16 v[40:41], v6 offset:14048
    ds_read_b64_tr_b16 v[42:43], v6 offset:15200
    s_waitcnt lgkmcnt(8)
    v_mfma_f32_32x32x16_bf16 v[160:175], v[24:27], v[60:63], v[160:175]
    ds_read_b64_tr_b16 v[44:45], v6 offset:14080
    ds_read_b64_tr_b16 v[46:47], v6 offset:15232
    s_waitcnt lgkmcnt(8)
    v_mfma_f32_32x32x16_bf16 v[176:191], v[28:31], v[60:63], v[176:191]
    ds_read_b64_tr_b16 v[24:25], v6 offset:37120
    ds_read_b64_tr_b16 v[26:27], v6 offset:38272
    s_waitcnt lgkmcnt(8)
    v_mfma_f32_32x32x16_bf16 v[192:207], v[32:35], v[60:63], v[192:207]
    ds_read_b64_tr_b16 v[28:29], v6 offset:41728
    ds_read_b64_tr_b16 v[30:31], v6 offset:42880
    s_waitcnt lgkmcnt(8)
    v_mfma_f32_32x32x16_bf16 v[208:223], v[36:39], v[60:63], v[208:223]
    ds_read_b64_tr_b16 v[32:33], v6 offset:46336
    ds_read_b64_tr_b16 v[34:35], v6 offset:47488
    s_waitcnt lgkmcnt(8)
    v_mfma_f32_32x32x16_bf16 v[224:239], v[40:43], v[60:63], v[224:239]
    ds_read_b64_tr_b16 v[36:37], v6 offset:50944
    ds_read_b64_tr_b16 v[38:39], v6 offset:52096
    s_waitcnt lgkmcnt(8)
    v_mfma_f32_32x32x16_bf16 v[240:255], v[44:47], v[60:63], v[240:255]
    buffer_load_dwordx4 v[60:63], v8, s[24:27], s33 offen offset:3072 sc1
    s_add_u32 s33, s33, 4096
KB_tc5:
    v_max3_u32 v12, v64, v65, v66
    v_max3_u32 v13, v67, v68, v69
    v_max3_u32 v14, v70, v71, v72
    v_max3_u32 v12, v12, v73, v74
    v_max3_u32 v13, v13, v75, v76
    v_max3_u32 v14, v14, v77, v78
    v_max3_u32 v12, v12, v13, v79
    v_max_u32 v12, v12, v14
    v_cmp_eq_u32 vcc, -1, v12
    s_nop 1
    s_cbranch_vccnz KB_tr5
KB_tb5:
    s_waitcnt lgkmcnt(6)
    v_mfma_f32_32x32x16_bf16 v[112:127], v[24:27], v[64:67], v[112:127]
    s_waitcnt vmcnt(4)
    s_barrier
    s_waitcnt lgkmcnt(4)
    v_mfma_f32_32x32x16_bf16 v[112:127], v[28:31], v[68:71], v[112:127]
    ds_read_b64_tr_b16 v[40:41], v7 offset:0
    ds_read_b64_tr_b16 v[42:43], v7 offset:1152
    ds_read_b64_tr_b16 v[44:45], v7 offset:4608
    ds_read_b64_tr_b16 v[46:47], v7 offset:5760
    s_waitcnt lgkmcnt(6)
    v_mfma_f32_32x32x16_bf16 v[112:127], v[32:35], v[72:75], v[112:127]
    ds_read_b64_tr_b16 v[24:25], v7 offset:9216
    ds_read_b64_tr_b16 v[26:27], v7 offset:10368
    ds_read_b64_tr_b16 v[28:29], v7 offset:13824
    ds_read_b64_tr_b16 v[30:31], v7 offset:14976
    s_add_u32 m0, s16, 0
    s_nop 0
    buffer_load_dwordx4 v1, s[4:7], s32 offen lds
    s_waitcnt lgkmcnt(8)
    v_mfma_f32_32x32x16_bf16 v[112:127], v[36:39], v[76:79], v[112:127]
    ds_read_b64_tr_b16 v[32:33], v7 offset:37120
    ds_read_b64_tr_b16 v[34:35], v7 offset:38272
KB_tc6:
    v_max3_u32 v12, v80, v81, v82
    v_max3_u32 v13, v83, v84, v85
    v_max3_u32 v14, v86, v87, v88
    v_max3_u32 v12, v12, v89, v90
    v_max3_u32 v13, v13, v91, v92
    v_max3_u32 v14, v14, v93, v94
    v_max3_u32 v12, v12, v13, v95
    v_max_u32 v12, v12, v14
    v_cmp_eq_u32 vcc, -1, v12
    s_nop 1
    s_cbranch_vccnz KB_tr6
KB_tb6:
    s_waitcnt lgkmcnt(8)
    v_mfma_f32_32x32x16_bf16 v[112:127], v[40:43], v[80:83], v[112:127]
    ds_read_b64_tr_b16 v[36:37], v7 offset:41728
    ds_read_b64_tr_b16 v[38:39], v7 offset:42880
    buffer_load_dwordx4 v2, s[4:7], s32 offen offset:1024 lds
    s_waitcnt lgkmcnt(8)
    v_mfma_f32_32x32x16_bf16 v[112:127], v[44:47], v[84:87], v[112:127]
    ds_read_b64_tr_b16 v[40:41], v7 offset:46336
    ds_read_b64_tr_b16 v[42:43], v7 offset:47488
    s_waitcnt lgkmcnt(8)
    v_mfma_f32_32x32x16_bf16 v[112:127], v[24:27], v[88:91], v[112:127]
    ds_read_b64_tr_b16 v[44:45], v7 offset:50944
    ds_read_b64_tr_b16 v[46:47], v7 offset:52096
    buffer_load_dwordx4 v3, s[4:7], s32 offen offset:2048 lds
    s_waitcnt lgkmcnt(8)
    v_mfma_f32_32x32x16_bf16 v[112:127], v[28:31], v[92:95], v[112:127]
    ds_read_b64_tr_b16 v[24:25], v6 offset:37152
    ds_read_b64_tr_b16 v[26:27], v6 offset:38304
KB_tc7:
    v_max3_u32 v12, v96, v97, v98
    v_max3_u32 v13, v99, v100, v101
    v_max3_u32 v14, v102, v103, v104
    v_max3_u32 v12, v12, v105, v106
    v_max3_u32 v13, v13, v107, v108
    v_max3_u32 v14, v14, v109, v110
    v_max3_u32 v12, v12, v13, v111
    v_max_u32 v12, v12, v14
    v_cmp_eq_u32 vcc, -1, v12
    s_nop 1
    s_cbranch_vccnz KB_tr7
KB_tb7:
    s_waitcnt lgkmcnt(8)
    v_mfma_f32_32x32x16_bf16 v[112:127], v[32:35], v[96:99], v[112:127]
    ds_read_b64_tr_b16 v[28:29], v6 offset:41760
    ds_read_b64_tr_b16 v[30:31], v6 offset:42912
    buffer_load_dwordx4 v4, s[4:7], s32 offen offset:3072 lds
    s_waitcnt lgkmcnt(8)
    v_mfma_f32_32x32x16_bf16 v[112:127], v[36:39], v[100:103], v[112:127]
    ds_read_b64_tr_b16 v[32:33], v6 offset:46368
    ds_read_b64_tr_b16 v[34:35], v6 offset:47520
    s_waitcnt lgkmcnt(8)
    v_mfma_f32_32x32x16_bf16 v[112:127], v[40:43], v[104:107], v[112:127]
    ds_read_b64_tr_b16 v[36:37], v6 offset:50976
    ds_read_b64_tr_b16 v[38:39], v6 offset:52128
    s_add_u32 s34, s35, 0
    s_cmp_eq_u32 s19, 1
    s_cselect_b32 m0, 148480, s34
    s_nop 0
    buffer_load_dwordx4 v5, s[4:7], s32 offen lds
    s_add_u32 s32, s32, 589824
    s_waitcnt lgkmcnt(8)
    v_mfma_f32_32x32x16_bf16 v[112:127], v[44:47], v[108:111], v[112:127]
    ds_read_b64_tr_b16 v[40:41], v7 offset:32
    ds_read_b64_tr_b16 v[42:43], v7 offset:1184
    s_waitcnt lgkmcnt(8)
    v_mfma_f32_32x32x16_bf16 v[128:143], v[24:27], v[64:67], v[128:143]
    ds_read_b64_tr_b16 v[44:45], v7 offset:4640
    ds_read_b64_tr_b16 v[46:47], v7 offset:5792
    s_waitcnt lgkmcnt(8)
    v_mfma_f32_32x32x16_bf16 v[128:143], v[28:31], v[68:71], v[128:143]
    ds_read_b64_tr_b16 v[24:25], v7 offset:9248
    ds_read_b64_tr_b16 v[26:27], v7 offset:10400
    s_waitcnt lgkmcnt(8)
    v_mfma_f32_32x32x16_bf16 v[128:143], v[32:35], v[72:75], v[128:143]
    ds_read_b64_tr_b16 v[28:29], v7 offset:13856
    ds_read_b64_tr_b16 v[30:31], v7 offset:15008
    s_waitcnt lgkmcnt(8)
    v_mfma_f32_32x32x16_bf16 v[128:143], v[36:39], v[76:79], v[128:143]
    ds_read_b64_tr_b16 v[32:33], v7 offset:37152
    ds_read_b64_tr_b16 v[34:35], v7 offset:38304
    s_waitcnt lgkmcnt(8)
    v_mfma_f32_32x32x16_bf16 v[128:143], v[40:43], v[80:83], v[128:143]
    ds_read_b64_tr_b16 v[36:37], v7 offset:41760
    ds_read_b64_tr_b16 v[38:39], v7 offset:42912
    s_waitcnt lgkmcnt(8)
    v_mfma_f32_32x32x16_bf16 v[128:143], v[44:47], v[84:87], v[128:143]
    ds_read_b64_tr_b16 v[40:41], v7 offset:46368
    ds_read_b64_tr_b16 v[42:43], v7 offset:47520
    s_waitcnt lgkmcnt(8)
    v_mfma_f32_32x32x16_bf16 v[128:143], v[24:27], v[88:91], v[128:143]
    ds_read_b64_tr_b16 v[44:45], v7 offset:50976
    ds_read_b64_tr_b16 v[46:47], v7 offset:52128
    s_waitcnt lgkmcnt(8)
    v_mfma_f32_32x32x16_bf16 v[128:143], v[28:31], v[92:95], v[128:143]
    ds_read_b64_tr_b16 v[24:25], v6 offset:37184
    ds_read_b64_tr_b16 v[26:27], v6 offset:38336
    s_waitcnt lgkmcnt(8)
    v_mfma_f32_32x32x16_bf16 v[128:143], v[32:35], v[96:99], v[128:143]
    ds_read_b64_tr_b16 v[28:29], v6 offset:41792
    ds_read_b64_tr_b16 v[30:31], v6 offset:42944
    s_waitcnt lgkmcnt(8)
    v_mfma_f32_32x32x16_bf16 v[128:143], v[36:39], v[100:103], v[128:143]
    ds_read_b64_tr_b16 v[32:33], v6 offset:46400
    ds_read_b64_tr_b16 v[34:35], v6 offset:47552
    s_waitcnt lgkmcnt(8)
    v_mfma_f32_32x32x16_bf16 v[128:143], v[40:43], v[104:107], v[128:143]
    ds_read_b64_tr_b16 v[36:37], v6 offset:51008
    ds_read_b64_tr_b16 v[38:39], v6 offset:52160
    s_waitcnt lgkmcnt(8)
    v_mfma_f32_32x32x16_bf16 v[128:143], v[44:47], v[108:111], v[128:143]
    ds_read_b64_tr_b16 v[40:41], v7 offset:64
    ds_read_b64_tr_b16 v[42:43], v7 offset:1216
    s_waitcnt lgkmcnt(8)
    v_mfma_f32_32x32x16_bf16 v[144:159], v[24:27], v[64:67], v[144:159]
    ds_read_b64_tr_b16 v[44:45], v7 offset:4672
    ds_read_b64_tr_b16 v[46:47], v7 offset:5824
    s_waitcnt lgkmcnt(8)
    v_mfma_f32_32x32x16_bf16 v[144:159], v[28:31], v[68:71], v[144:159]
    ds_read_b64_tr_b16 v[24:25], v7 offset:9280
    ds_read_b64_tr_b16 v[26:27], v7 offset:10432
    s_waitcnt lgkmcnt(8)
    v_mfma_f32_32x32x16_bf16 v[144:159], v[32:35], v[72:75], v[144:159]
    ds_read_b64_tr_b16 v[28:29], v7 offset:13888
    ds_read_b64_tr_b16 v[30:31], v7 offset:15040
    s_waitcnt lgkmcnt(8)
    v_mfma_f32_32x32x16_bf16 v[144:159], v[36:39], v[76:79], v[144:159]
    ds_read_b64_tr_b16 v[32:33], v7 offset:37184
    ds_read_b64_tr_b16 v[34:35], v7 offset:38336
    s_waitcnt lgkmcnt(8)
    v_mfma_f32_32x32x16_bf16 v[144:159], v[40:43], v[80:83], v[144:159]
    ds_read_b64_tr_b16 v[36:37], v7 offset:41792
    ds_read_b64_tr_b16 v[38:39], v7 offset:42944
    s_waitcnt lgkmcnt(8)
    v_mfma_f32_32x32x16_bf16 v[144:159], v[44:47], v[84:87], v[144:159]
    ds_read_b64_tr_b16 v[40:41], v7 offset:46400
    ds_read_b64_tr_b16 v[42:43], v7 offset:47552
    s_waitcnt vmcnt(0)
    s_barrier
    s_waitcnt lgkmcnt(8)
    v_mfma_f32_32x32x16_bf16 v[144:159], v[24:27], v[88:91], v[144:159]
    ds_read_b64_tr_b16 v[44:45], v7 offset:51008
    ds_read_b64_tr_b16 v[46:47], v7 offset:52160
    s_waitcnt lgkmcnt(8)
    v_mfma_f32_32x32x16_bf16 v[144:159], v[28:31], v[92:95], v[144:159]
    ds_read_b64_tr_b16 v[24:25], v6 offset:0
    ds_read_b64_tr_b16 v[26:27], v6 offset:1152
    s_waitcnt lgkmcnt(8)
    v_mfma_f32_32x32x16_bf16 v[144:159], v[32:35], v[96:99], v[144:159]
    ds_read_b64_tr_b16 v[28:29], v6 offset:4608
    ds_read_b64_tr_b16 v[30:31], v6 offset:5760
    s_waitcnt lgkmcnt(8)
    v_mfma_f32_32x32x16_bf16 v[144:159], v[36:39], v[100:103], v[144:159]
    ds_read_b64_tr_b16 v[32:33], v6 offset:9216
    ds_read_b64_tr_b16 v[34:35], v6 offset:10368
    s_waitcnt lgkmcnt(8)
    v_mfma_f32_32x32x16_bf16 v[144:159], v[40:43], v[104:107], v[144:159]
    ds_read_b64_tr_b16 v[36:37], v6 offset:13824
    ds_read_b64_tr_b16 v[38:39], v6 offset:14976
    s_waitcnt lgkmcnt(8)
    v_mfma_f32_32x32x16_bf16 v[144:159], v[44:47], v[108:111], v[144:159]
    ds_read_b64_tr_b16 v[40:41], v6 offset:32
    ds_read_b64_tr_b16 v[42:43], v6 offset:1184
KB_tc8:
    v_max3_u32 v12, v48, v49, v50
    v_max3_u32 v13, v51, v52, v53
    v_max3_u32 v14, v54, v55, v56
    v_max3_u32 v12, v12, v57, v58
    v_max3_u32 v13, v13, v59, v60
    v_max3_u32 v14, v14, v61, v62
    v_max3_u32 v12, v12, v13, v63
    v_max_u32 v12, v12, v14
    v_cmp_eq_u32 vcc, -1, v12
    s_nop 1
    s_cbranch_vccnz KB_tr8
KB_tb8:
    s_waitcnt lgkmcnt(8)
    v_mfma_f32_32x32x16_bf16 v[112:127], v[24:27], v[48:51], v[112:127]
    ds_read_b64_tr_b16 v[44:45], v6 offset:4640
    ds_read_b64_tr_b16 v[46:47], v6 offset:5792
    s_waitcnt lgkmcnt(8)
    v_mfma_f32_32x32x16_bf16 v[112:127], v[28:31], v[52:55], v[112:127]
    ds_read_b64_tr_b16 v[24:25], v6 offset:9248
    ds_read_b64_tr_b16 v[26:27], v6 offset:10400
    s_waitcnt lgkmcnt(8)
    v_mfma_f32_32x32x16_bf16 v[112:127], v[32:35], v[56:59], v[112:127]
    ds_read_b64_tr_b16 v[28:29], v6 offset:13856
    ds_read_b64_tr_b16 v[30:31], v6 offset:15008
    s_waitcnt lgkmcnt(8)
    v_mfma_f32_32x32x16_bf16 v[112:127], v[36:39], v[60:63], v[112:127]
    ds_read_b64_tr_b16 v[32:33], v6 offset:64
    ds_read_b64_tr_b16 v[34:35], v6 offset:1216
    s_waitcnt lgkmcnt(8)
    v_mfma_f32_32x32x16_bf16 v[128:143], v[40:43], v[48:51], v[128:143]
    ds_read_b64_tr_b16 v[36:37], v6 offset:4672
    ds_read_b64_tr_b16 v[38:39], v6 offset:5824
    s_waitcnt lgkmcnt(8)
    v_mfma_f32_32x32x16_bf16 v[128:143], v[44:47], v[52:55], v[128:143]
    ds_read_b64_tr_b16 v[40:41], v6 offset:9280
    ds_read_b64_tr_b16 v[42:43], v6 offset:10432
    s_nop 1
    v_mul_f32 v12, v112, v112
    v_mul_f32 v13, v113, v113
    v_mul_f32 v14, v114, v114
    v_mul_f32 v15, v115, v115
    v_mul_f32 v16, v120, v120
    v_mul_f32 v17, v121, v121
    v_mul_f32 v18, v122, v122
    s_waitcnt lgkmcnt(8)
    v_mfma_f32_32x32x16_bf16 v[128:143], v[24:27], v[56:59], v[128:143]
    ds_read_b64_tr_b16 v[44:45], v6 offset:13888
    ds_read_b64_tr_b16 v[46:47], v6 offset:15040
    v_mul_f32 v19, v123, v123
    v_fmaak_f32 v12, v10, v12, 0xc0135761
    v_fmaak_f32 v13, v10, v13, 0xc0135761
    v_fmaak_f32 v14, v10, v14, 0xc0135761
    v_fmaak_f32 v15, v10, v15, 0xc0135761
    v_fmaak_f32 v16, v10, v16, 0xc0135761
    v_fmaak_f32 v17, v10, v17, 0xc0135761
    s_waitcnt lgkmcnt(8)
    v_mfma_f32_32x32x16_bf16 v[128:143], v[28:31], v[60:63], v[128:143]
    ds_read_b64_tr_b16 v[24:25], v6 offset:37216
    ds_read_b64_tr_b16 v[26:27], v6 offset:38368
    v_fmaak_f32 v18, v10, v18, 0xc0135761
    v_fmaak_f32 v19, v10, v19, 0xc0135761
    v_mul_f32 v12, v12, v112
    v_mul_f32 v13, v13, v113
    v_mul_f32 v14, v14, v114
    v_mul_f32 v15, v15, v115
    v_mul_f32 v16, v16, v120
    s_waitcnt lgkmcnt(8)
    v_mfma_f32_32x32x16_bf16 v[144:159], v[32:35], v[48:51], v[144:159]
    ds_read_b64_tr_b16 v[28:29], v6 offset:41824
    ds_read_b64_tr_b16 v[30:31], v6 offset:42976
    v_mul_f32 v17, v17, v121
    v_mul_f32 v18, v18, v122
    v_mul_f32 v19, v19, v123
    v_exp_f32 v12, v12
    v_mul_f32 v116, v112, v116
    v_exp_f32 v13, v13
    s_waitcnt lgkmcnt(8)
    v_mfma_f32_32x32x16_bf16 v[144:159], v[36:39], v[52:55], v[144:159]
    ds_read_b64_tr_b16 v[32:33], v6 offset:46432
    ds_read_b64_tr_b16 v[34:35], v6 offset:47584
    v_mul_f32 v117, v113, v117
    v_exp_f32 v14, v14
    v_mul_f32 v118, v114, v118
    v_exp_f32 v15, v15
    v_mul_f32 v119, v115, v119
    s_waitcnt lgkmcnt(8)
    v_mfma_f32_32x32x16_bf16 v[144:159], v[40:43], v[56:59], v[144:159]
    ds_read_b64_tr_b16 v[36:37], v6 offset:51040
    ds_read_b64_tr_b16 v[38:39], v6 offset:52192
    v_exp_f32 v16, v16
    v_mul_f32 v124, v120, v124
    v_exp_f32 v17, v17
    v_mul_f32 v125, v121, v125
    v_exp_f32 v18, v18
    s_waitcnt lgkmcnt(8)
    v_mfma_f32_32x32x16_bf16 v[144:159], v[44:47], v[60:63], v[144:159]
    ds_read_b64_tr_b16 v[40:41], v7 offset:96
    ds_read_b64_tr_b16 v[42:43], v7 offset:1248
    v_mul_f32 v126, v122, v126
    v_exp_f32 v19, v19
    v_mul_f32 v127, v123, v127
    v_add_f32 v12, 1.0, v12
    v_add_f32 v13, 1.0, v13
    v_add_f32 v14, 1.0, v14
    s_waitcnt lgkmcnt(8)
    v_mfma_f32_32x32x16_bf16 v[160:175], v[24:27], v[64:67], v[160:175]
    ds_read_b64_tr_b16 v[44:45], v7 offset:4704
    ds_read_b64_tr_b16 v[46:47], v7 offset:5856
    v_add_f32 v15, 1.0, v15
    v_add_f32 v16, 1.0, v16
    v_add_f32 v17, 1.0, v17
    v_add_f32 v18, 1.0, v18
    v_add_f32 v19, 1.0, v19
    v_rcp_f32 v12, v12
    s_waitcnt lgkmcnt(8)
    v_mfma_f32_32x32x16_bf16 v[160:175], v[28:31], v[68:71], v[160:175]
    ds_read_b64_tr_b16 v[24:25], v7 offset:9312
    ds_read_b64_tr_b16 v[26:27], v7 offset:10464
    v_rcp_f32 v13, v13
    v_rcp_f32 v14, v14
    v_mul_f32 v12, v12, v116
    v_rcp_f32 v15, v15
    s_waitcnt lgkmcnt(8)
    v_mfma_f32_32x32x16_bf16 v[160:175], v[32:35], v[72:75], v[160:175]
    ds_read_b64_tr_b16 v[28:29], v7 offset:13920
    ds_read_b64_tr_b16 v[30:31], v7 offset:15072
    v_mul_f32 v13, v13, v117
    v_rcp_f32 v16, v16
    v_mul_f32 v14, v14, v118
    v_rcp_f32 v17, v17
    v_mul_f32 v15, v15, v119
    s_waitcnt lgkmcnt(8)
    v_mfma_f32_32x32x16_bf16 v[160:175], v[36:39], v[76:79], v[160:175]
    ds_read_b64_tr_b16 v[32:33], v7 offset:37216
    ds_read_b64_tr_b16 v[34:35], v7 offset:38368
    v_rcp_f32 v18, v18
    v_mul_f32 v16, v16, v124
    v_rcp_f32 v19, v19
    v_mul_f32 v17, v17, v125
    v_mul_f32 v18, v18, v126
    s_waitcnt lgkmcnt(8)
    v_mfma_f32_32x32x16_bf16 v[160:175], v[40:43], v[80:83], v[160:175]
    ds_read_b64_tr_b16 v[36:37], v7 offset:41824
    ds_read_b64_tr_b16 v[38:39], v7 offset:42976
    v_mul_f32 v19, v19, v127
    v_cvt_pk_bf16_f32 v20, v12, v13
    v_cvt_pk_bf16_f32 v21, v14, v15
    v_cvt_pk_bf16_f32 v22, v16, v17
    v_cvt_pk_bf16_f32 v23, v18, v19
    buffer_store_dwordx4 v[20:23], v9, s[28:31], s37 offen sc1
    s_add_u32 s37, s37, 512
    s_add_u32 s95, s95, 1
    s_cmp_eq_u32 s95, 9
    s_cselect_b32 s94, 4608, 0
    s_sub_u32 s37, s37, s94
    s_waitcnt lgkmcnt(8)
    v_mfma_f32_32x32x16_bf16 v[160:175], v[44:47], v[84:87], v[160:175]
    ds_read_b64_tr_b16 v[40:41], v7 offset:46432
    ds_read_b64_tr_b16 v[42:43], v7 offset:47584
    ds_read_b64_tr_b16 v[112:113], v7 offset:51040
    ds_read_b64_tr_b16 v[114:115], v7 offset:52192
    v_mul_f32 v12, v128, v128
    v_mul_f32 v13, v129, v129
    v_mul_f32 v14, v130, v130
    v_mul_f32 v15, v131, v131
    v_mul_f32 v16, v136, v136
    v_mul_f32 v17, v137, v137
    v_mul_f32 v18, v138, v138
    s_waitcnt lgkmcnt(10)
    v_mfma_f32_32x32x16_bf16 v[160:175], v[24:27], v[88:91], v[160:175]
    ds_read_b64_tr_b16 v[116:117], v6 offset:96
    ds_read_b64_tr_b16 v[118:119], v6 offset:1248
    ds_read_b64_tr_b16 v[120:121], v6 offset:4704
    ds_read_b64_tr_b16 v[122:123], v6 offset:5856
    v_mul_f32 v19, v139, v139
    v_fmaak_f32 v12, v10, v12, 0xc0135761
    v_fmaak_f32 v13, v10, v13, 0xc0135761
    v_fmaak_f32 v14, v10, v14, 0xc0135761
    v_fmaak_f32 v15, v10, v15, 0xc0135761
    v_fmaak_f32 v16, v10, v16, 0xc0135761
    v_fmaak_f32 v17, v10, v17, 0xc0135761
    s_waitcnt lgkmcnt(12)
    v_mfma_f32_32x32x16_bf16 v[160:175], v[28:31], v[92:95], v[160:175]
    ds_read_b64_tr_b16 v[124:125], v6 offset:9312
    ds_read_b64_tr_b16 v[126:127], v6 offset:10464
    ds_read_b64_tr_b16 v[44:45], v6 offset:13920
    ds_read_b64_tr_b16 v[46:47], v6 offset:15072
    v_fmaak_f32 v18, v10, v18, 0xc0135761
    v_fmaak_f32 v19, v10, v19, 0xc0135761
    v_mul_f32 v12, v12, v128
    v_mul_f32 v13, v13, v129
    v_mul_f32 v14, v14, v130
    v_mul_f32 v15, v15, v131
    v_mul_f32 v16, v16, v136
    s_waitcnt lgkmcnt(14)
    v_mfma_f32_32x32x16_bf16 v[160:175], v[32:35], v[96:99], v[160:175]
    ds_read_b64_tr_b16 v[24:25], v6 offset:37248
    ds_read_b64_tr_b16 v[26:27], v6 offset:38400
    v_mul_f32 v17, v17, v137
    v_mul_f32 v18, v18, v138
    v_mul_f32 v19, v19, v139
    v_exp_f32 v12, v12
    v_mul_f32 v132, v128, v132
    v_exp_f32 v13, v13
    s_waitcnt lgkmcnt(14)
    v_mfma_f32_32x32x16_bf16 v[160:175], v[36:39], v[100:103], v[160:175]
    ds_read_b64_tr_b16 v[28:29], v6 offset:41856
    ds_read_b64_tr_b16 v[30:31], v6 offset:43008
    v_mul_f32 v133, v129, v133
    v_exp_f32 v14, v14
    v_mul_f32 v134, v130, v134
    v_exp_f32 v15, v15
    v_mul_f32 v135, v131, v135
    s_waitcnt lgkmcnt(14)
    v_mfma_f32_32x32x16_bf16 v[160:175], v[40:43], v[104:107], v[160:175]
    ds_read_b64_tr_b16 v[32:33], v6 offset:46464
    ds_read_b64_tr_b16 v[34:35], v6 offset:47616
    v_exp_f32 v16, v16
    v_mul_f32 v140, v136, v140
    v_exp_f32 v17, v17
    v_mul_f32 v141, v137, v141
    v_exp_f32 v18, v18
    s_waitcnt lgkmcnt(14)
    v_mfma_f32_32x32x16_bf16 v[160:175], v[112:115], v[108:111], v[160:175]
    ds_read_b64_tr_b16 v[36:37], v6 offset:51072
    ds_read_b64_tr_b16 v[38:39], v6 offset:52224
    v_mul_f32 v142, v138, v142
    v_exp_f32 v19, v19
    v_mul_f32 v143, v139, v143
    v_add_f32 v12, 1.0, v12
    v_add_f32 v13, 1.0, v13
    v_add_f32 v14, 1.0, v14
    s_waitcnt lgkmcnt(14)
    v_mfma_f32_32x32x16_bf16 v[160:175], v[116:119], v[48:51], v[160:175]
    ds_read_b64_tr_b16 v[40:41], v7 offset:128
    ds_read_b64_tr_b16 v[42:43], v7 offset:1280
    v_add_f32 v15, 1.0, v15
    v_add_f32 v16, 1.0, v16
    v_add_f32 v17, 1.0, v17
    v_add_f32 v18, 1.0, v18
    v_add_f32 v19, 1.0, v19
    v_rcp_f32 v12, v12
    s_waitcnt lgkmcnt(14)
    v_mfma_f32_32x32x16_bf16 v[160:175], v[120:123], v[52:55], v[160:175]
    ds_read_b64_tr_b16 v[112:113], v7 offset:4736
    ds_read_b64_tr_b16 v[114:115], v7 offset:5888
    v_rcp_f32 v13, v13
    v_rcp_f32 v14, v14
    v_mul_f32 v12, v12, v132
    v_rcp_f32 v15, v15
    s_waitcnt lgkmcnt(14)
    v_mfma_f32_32x32x16_bf16 v[160:175], v[124:127], v[56:59], v[160:175]
    ds_read_b64_tr_b16 v[116:117], v7 offset:9344
    ds_read_b64_tr_b16 v[118:119], v7 offset:10496
    v_mul_f32 v13, v13, v133
    v_rcp_f32 v16, v16
    v_mul_f32 v14, v14, v134
    v_rcp_f32 v17, v17
    v_mul_f32 v15, v15, v135
    s_waitcnt lgkmcnt(14)
    v_mfma_f32_32x32x16_bf16 v[160:175], v[44:47], v[60:63], v[160:175]
    ds_read_b64_tr_b16 v[120:121], v7 offset:13952
    ds_read_b64_tr_b16 v[122:123], v7 offset:15104
    v_rcp_f32 v18, v18
    v_mul_f32 v16, v16, v140
    v_rcp_f32 v19, v19
    v_mul_f32 v17, v17, v141
    v_mul_f32 v18, v18, v142
    s_waitcnt lgkmcnt(14)
    v_mfma_f32_32x32x16_bf16 v[176:191], v[24:27], v[64:67], v[176:191]
    ds_read_b64_tr_b16 v[124:125], v7 offset:37248
    ds_read_b64_tr_b16 v[126:127], v7 offset:38400
    v_mul_f32 v19, v19, v143
    v_cvt_pk_bf16_f32 v20, v12, v13
    v_cvt_pk_bf16_f32 v21, v14, v15
    v_cvt_pk_bf16_f32 v22, v16, v17
    v_cvt_pk_bf16_f32 v23, v18, v19
    buffer_store_dwordx4 v[20:23], v9, s[28:31], s37 offen sc1
    s_add_u32 s37, s37, 512
    s_add_u32 s95, s95, 1
    s_cmp_eq_u32 s95, 9
    s_cselect_b32 s94, 4608, 0
    s_sub_u32 s37, s37, s94
    s_waitcnt lgkmcnt(14)
    v_mfma_f32_32x32x16_bf16 v[176:191], v[28:31], v[68:71], v[176:191]
    ds_read_b64_tr_b16 v[44:45], v7 offset:41856
    ds_read_b64_tr_b16 v[46:47], v7 offset:43008
    v_mul_f32 v12, v144, v144
    v_mul_f32 v13, v145, v145
    v_mul_f32 v14, v146, v146
    v_mul_f32 v15, v147, v147
    v_mul_f32 v16, v152, v152
    v_mul_f32 v17, v153, v153
    v_mul_f32 v18, v154, v154
    s_waitcnt lgkmcnt(14)
    v_mfma_f32_32x32x16_bf16 v[176:191], v[32:35], v[72:75], v[176:191]
    ds_read_b64_tr_b16 v[24:25], v7 offset:46464
    ds_read_b64_tr_b16 v[26:27], v7 offset:47616
    v_mul_f32 v19, v155, v155
    v_fmaak_f32 v12, v10, v12, 0xc0135761
    v_fmaak_f32 v13, v10, v13, 0xc0135761
    v_fmaak_f32 v14, v10, v14, 0xc0135761
    v_fmaak_f32 v15, v10, v15, 0xc0135761
    v_fmaak_f32 v16, v10, v16, 0xc0135761
    v_fmaak_f32 v17, v10, v17, 0xc0135761
    s_waitcnt lgkmcnt(14)
    v_mfma_f32_32x32x16_bf16 v[176:191], v[36:39], v[76:79], v[176:191]
    ds_read_b64_tr_b16 v[128:129], v7 offset:51072
    ds_read_b64_tr_b16 v[130:131], v7 offset:52224
    v_fmaak_f32 v18, v10, v18, 0xc0135761
    v_fmaak_f32 v19, v10, v19, 0xc0135761
    v_mul_f32 v12, v12, v144
    v_mul_f32 v13, v13, v145
    v_mul_f32 v14, v14, v146
    v_mul_f32 v15, v15, v147
    v_mul_f32 v16, v16, v152
    s_waitcnt lgkmcnt(14)
    v_mfma_f32_32x32x16_bf16 v[176:191], v[40:43], v[80:83], v[176:191]
    ds_read_b64_tr_b16 v[132:133], v6 offset:128
    ds_read_b64_tr_b16 v[134:135], v6 offset:1280
    v_mul_f32 v17, v17, v153
    v_mul_f32 v18, v18, v154
    v_mul_f32 v19, v19, v155
    v_exp_f32 v12, v12
    v_mul_f32 v148, v144, v148
    v_exp_f32 v13, v13
    s_waitcnt lgkmcnt(14)
    v_mfma_f32_32x32x16_bf16 v[176:191], v[112:115], v[84:87], v[176:191]
    ds_read_b64_tr_b16 v[136:137], v6 offset:4736
    ds_read_b64_tr_b16 v[138:139], v6 offset:5888
    v_mul_f32 v149, v145, v149
    v_exp_f32 v14, v14
    v_mul_f32 v150, v146, v150
    v_exp_f32 v15, v15
    v_mul_f32 v151, v147, v151
    s_waitcnt lgkmcnt(14)
    v_mfma_f32_32x32x16_bf16 v[176:191], v[116:119], v[88:91], v[176:191]
    ds_read_b64_tr_b16 v[140:141], v6 offset:9344
    ds_read_b64_tr_b16 v[142:143], v6 offset:10496
    v_exp_f32 v16, v16
    v_mul_f32 v156, v152, v156
    v_exp_f32 v17, v17
    v_mul_f32 v157, v153, v157
    v_exp_f32 v18, v18
    s_waitcnt lgkmcnt(14)
    v_mfma_f32_32x32x16_bf16 v[176:191], v[120:123], v[92:95], v[176:191]
    ds_read_b64_tr_b16 v[28:29], v6 offset:13952
    ds_read_b64_tr_b16 v[30:31], v6 offset:15104
    v_mul_f32 v158, v154, v158
    v_exp_f32 v19, v19
    v_mul_f32 v159, v155, v159
    v_add_f32 v12, 1.0, v12
    v_add_f32 v13, 1.0, v13
    v_add_f32 v14, 1.0, v14
    s_waitcnt lgkmcnt(14)
    v_mfma_f32_32x32x16_bf16 v[176:191], v[124:127], v[96:99], v[176:191]
    ds_read_b64_tr_b16 v[32:33], v6 offset:37280
    ds_read_b64_tr_b16 v[34:35], v6 offset:38432
    v_add_f32 v15, 1.0, v15
    v_add_f32 v16, 1.0, v16
    v_add_f32 v17, 1.0, v17
    v_add_f32 v18, 1.0, v18
    v_add_f32 v19, 1.0, v19
    v_rcp_f32 v12, v12
    s_waitcnt lgkmcnt(14)
    v_mfma_f32_32x32x16_bf16 v[176:191], v[44:47], v[100:103], v[176:191]
    ds_read_b64_tr_b16 v[36:37], v6 offset:41888
    ds_read_b64_tr_b16 v[38:39], v6 offset:43040
    v_rcp_f32 v13, v13
    v_rcp_f32 v14, v14
    v_mul_f32 v12, v12, v148
    v_rcp_f32 v15, v15
    s_waitcnt lgkmcnt(14)
    v_mfma_f32_32x32x16_bf16 v[176:191], v[24:27], v[104:107], v[176:191]
    ds_read_b64_tr_b16 v[40:41], v6 offset:46496
    ds_read_b64_tr_b16 v[42:43], v6 offset:47648
    v_mul_f32 v13, v13, v149
    v_rcp_f32 v16, v16
    v_mul_f32 v14, v14, v150
    v_rcp_f32 v17, v17
    v_mul_f32 v15, v15, v151
    s_waitcnt lgkmcnt(14)
    v_mfma_f32_32x32x16_bf16 v[176:191], v[128:131], v[108:111], v[176:191]
    ds_read_b64_tr_b16 v[112:113], v6 offset:51104
    ds_read_b64_tr_b16 v[114:115], v6 offset:52256
    v_rcp_f32 v18, v18
    v_mul_f32 v16, v16, v156
    v_rcp_f32 v19, v19
    v_mul_f32 v17, v17, v157
    v_mul_f32 v18, v18, v158
    s_waitcnt lgkmcnt(14)
    v_mfma_f32_32x32x16_bf16 v[176:191], v[132:135], v[48:51], v[176:191]
    ds_read_b64_tr_b16 v[116:117], v7 offset:160
    ds_read_b64_tr_b16 v[118:119], v7 offset:1312
    v_mul_f32 v19, v19, v159
    v_cvt_pk_bf16_f32 v20, v12, v13
    v_cvt_pk_bf16_f32 v21, v14, v15
    v_cvt_pk_bf16_f32 v22, v16, v17
    v_cvt_pk_bf16_f32 v23, v18, v19
    buffer_store_dwordx4 v[20:23], v9, s[28:31], s37 offen sc1
    s_add_u32 s37, s37, 512
    s_add_u32 s95, s95, 1
    s_cmp_eq_u32 s95, 9
    s_cselect_b32 s94, 4608, 0
    s_sub_u32 s37, s37, s94
    s_waitcnt lgkmcnt(14)
    v_mfma_f32_32x32x16_bf16 v[176:191], v[136:139], v[52:55], v[176:191]
    ds_read_b64_tr_b16 v[120:121], v7 offset:4768
    ds_read_b64_tr_b16 v[122:123], v7 offset:5920
    v_mul_f32 v12, v160, v160
    v_mul_f32 v13, v161, v161
    v_mul_f32 v14, v162, v162
    v_mul_f32 v15, v163, v163
    v_mul_f32 v16, v168, v168
    v_mul_f32 v17, v169, v169
    v_mul_f32 v18, v170, v170
    s_waitcnt lgkmcnt(14)
    v_mfma_f32_32x32x16_bf16 v[176:191], v[140:143], v[56:59], v[176:191]
    ds_read_b64_tr_b16 v[124:125], v7 offset:9376
    ds_read_b64_tr_b16 v[126:127], v7 offset:10528
    v_mul_f32 v19, v171, v171
    v_fmaak_f32 v12, v10, v12, 0xc0135761
    v_fmaak_f32 v13, v10, v13, 0xc0135761
    v_fmaak_f32 v14, v10, v14, 0xc0135761
    v_fmaak_f32 v15, v10, v15, 0xc0135761
    v_fmaak_f32 v16, v10, v16, 0xc0135761
    v_fmaak_f32 v17, v10, v17, 0xc0135761
    s_waitcnt lgkmcnt(14)
    v_mfma_f32_32x32x16_bf16 v[176:191], v[28:31], v[60:63], v[176:191]
    ds_read_b64_tr_b16 v[44:45], v7 offset:13984
    ds_read_b64_tr_b16 v[46:47], v7 offset:15136
    v_fmaak_f32 v18, v10, v18, 0xc0135761
    v_fmaak_f32 v19, v10, v19, 0xc0135761
    v_mul_f32 v12, v12, v160
    v_mul_f32 v13, v13, v161
    v_mul_f32 v14, v14, v162
    v_mul_f32 v15, v15, v163
    v_mul_f32 v16, v16, v168
    s_waitcnt lgkmcnt(14)
    v_mfma_f32_32x32x16_bf16 v[192:207], v[32:35], v[64:67], v[192:207]
    ds_read_b64_tr_b16 v[24:25], v7 offset:37280
    ds_read_b64_tr_b16 v[26:27], v7 offset:38432
    v_mul_f32 v17, v17, v169
    v_mul_f32 v18, v18, v170
    v_mul_f32 v19, v19, v171
    v_exp_f32 v12, v12
    v_mul_f32 v164, v160, v164
    v_exp_f32 v13, v13
    s_waitcnt lgkmcnt(14)
    v_mfma_f32_32x32x16_bf16 v[192:207], v[36:39], v[68:71], v[192:207]
    ds_read_b64_tr_b16 v[128:129], v7 offset:41888
    ds_read_b64_tr_b16 v[130:131], v7 offset:43040
    v_mul_f32 v165, v161, v165
    v_exp_f32 v14, v14
    v_mul_f32 v166, v162, v166
    v_exp_f32 v15, v15
    v_mul_f32 v167, v163, v167
    s_waitcnt lgkmcnt(14)
    v_mfma_f32_32x32x16_bf16 v[192:207], v[40:43], v[72:75], v[192:207]
    ds_read_b64_tr_b16 v[132:133], v7 offset:46496
    ds_read_b64_tr_b16 v[134:135], v7 offset:47648
    v_exp_f32 v16, v16
    v_mul_f32 v172, v168, v172
    v_exp_f32 v17, v17
    v_mul_f32 v173, v169, v173
    v_exp_f32 v18, v18
    s_waitcnt lgkmcnt(14)
    v_mfma_f32_32x32x16_bf16 v[192:207], v[112:115], v[76:79], v[192:207]
    ds_read_b64_tr_b16 v[136:137], v7 offset:51104
    ds_read_b64_tr_b16 v[138:139], v7 offset:52256
    v_mul_f32 v174, v170, v174
    v_exp_f32 v19, v19
    v_mul_f32 v175, v171, v175
    v_add_f32 v12, 1.0, v12
    v_add_f32 v13, 1.0, v13
    v_add_f32 v14, 1.0, v14
    s_waitcnt lgkmcnt(14)
    v_mfma_f32_32x32x16_bf16 v[192:207], v[116:119], v[80:83], v[192:207]
    ds_read_b64_tr_b16 v[140:141], v6 offset:160
    ds_read_b64_tr_b16 v[142:143], v6 offset:1312
    v_add_f32 v15, 1.0, v15
    v_add_f32 v16, 1.0, v16
    v_add_f32 v17, 1.0, v17
    v_add_f32 v18, 1.0, v18
    v_add_f32 v19, 1.0, v19
    v_rcp_f32 v12, v12
    s_waitcnt lgkmcnt(14)
    v_mfma_f32_32x32x16_bf16 v[192:207], v[120:123], v[84:87], v[192:207]
    ds_read_b64_tr_b16 v[28:29], v6 offset:4768
    ds_read_b64_tr_b16 v[30:31], v6 offset:5920
    v_rcp_f32 v13, v13
    v_rcp_f32 v14, v14
    v_mul_f32 v12, v12, v164
    v_rcp_f32 v15, v15
    s_waitcnt lgkmcnt(14)
    v_mfma_f32_32x32x16_bf16 v[192:207], v[124:127], v[88:91], v[192:207]
    ds_read_b64_tr_b16 v[32:33], v6 offset:9376
    ds_read_b64_tr_b16 v[34:35], v6 offset:10528
    v_mul_f32 v13, v13, v165
    v_rcp_f32 v16, v16
    v_mul_f32 v14, v14, v166
    v_rcp_f32 v17, v17
    v_mul_f32 v15, v15, v167
    s_waitcnt lgkmcnt(14)
    v_mfma_f32_32x32x16_bf16 v[192:207], v[44:47], v[92:95], v[192:207]
    ds_read_b64_tr_b16 v[36:37], v6 offset:13984
    ds_read_b64_tr_b16 v[38:39], v6 offset:15136
    v_rcp_f32 v18, v18
    v_mul_f32 v16, v16, v172
    v_rcp_f32 v19, v19
    v_mul_f32 v17, v17, v173
    v_mul_f32 v18, v18, v174
    s_waitcnt lgkmcnt(14)
    v_mfma_f32_32x32x16_bf16 v[192:207], v[24:27], v[96:99], v[192:207]
    ds_read_b64_tr_b16 v[40:41], v6 offset:37312
    ds_read_b64_tr_b16 v[42:43], v6 offset:38464
    v_mul_f32 v19, v19, v175
    v_cvt_pk_bf16_f32 v20, v12, v13
    v_cvt_pk_bf16_f32 v21, v14, v15
    v_cvt_pk_bf16_f32 v22, v16, v17
    v_cvt_pk_bf16_f32 v23, v18, v19
    buffer_store_dwordx4 v[20:23], v9, s[28:31], s37 offen sc1
    s_add_u32 s37, s37, 512
    s_add_u32 s95, s95, 1
    s_cmp_eq_u32 s95, 9
    s_cselect_b32 s94, 4608, 0
    s_sub_u32 s37, s37, s94
    s_mov_b32 s14, s13
    s_and_b32 s32, s2, 7
    s_lshr_b32 s13, s2, 3
    s_mul_i32 s19, s32, 29
    s_min_u32 s15, s32, 2
    s_add_u32 s19, s19, s15
    s_add_u32 s19, s19, s13
    s_mul_i32 s17, s19, 841
    s_lshr_b32 s17, s17, 16
    s_mul_i32 s15, s17, 78
    s_sub_u32 s18, s19, s15
    s_mul_i32 s15, s18, 21846
    s_lshr_b32 s15, s15, 16
    s_mul_i32 s16, s15, 3
    s_sub_u32 s16, s18, s16
    s_and_b32 s13, s3, 3
    s_mul_i32 s92, s12, 144
    s_mul_i32 s93, s92, 43691
    s_lshr_b32 s93, s93, 26
    s_add_u32 s92, s92, 143
    s_mul_i32 s92, s92, 43691
    s_lshr_b32 s92, s92, 26
    s_lshl_b32 s93, s93, 12
    s_lshl_b32 s92, s92, 12
    s_lshl_b32 s19, s14, 6
    s_add_u32 s93, s93, s19
    s_add_u32 s92, s92, s19
    s_mul_i32 s19, s15, 80
    s_lshr_b32 s91, s19, 5
    s_add_u32 s19, s19, 79
    s_lshr_b32 s19, s19, 5
    s_min_u32 s19, s19, 63
    s_sub_u32 s19, s19, s91
    s_add_u32 s19, s19, 1
    s_lshl_b32 s90, 1, s19
    s_sub_u32 s90, s90, 1
    s_lshl_b32 s91, s91, 6
    s_lshl_b32 s19, s17, 12
    s_add_u32 s91, s91, s19
    s_cmp_eq_u32 s17, 1
    s_cselect_b32 s89, 12, 11
    v_lshlrev_b32 v2, 6, v0
    v_mov_b32 v3, 0
    v_mov_b32 v4, 1
    s_waitcnt lgkmcnt(14)
    v_mfma_f32_32x32x16_bf16 v[192:207], v[128:131], v[100:103], v[192:207]
    ds_read_b64_tr_b16 v[112:113], v6 offset:41920
    ds_read_b64_tr_b16 v[114:115], v6 offset:43072
    v_mul_f32 v12, v176, v176
    v_mul_f32 v13, v177, v177
    v_mul_f32 v14, v178, v178
    v_mul_f32 v15, v179, v179
    v_mul_f32 v16, v184, v184
    v_mul_f32 v17, v185, v185
    v_mul_f32 v18, v186, v186
    s_waitcnt lgkmcnt(14)
    v_mfma_f32_32x32x16_bf16 v[192:207], v[132:135], v[104:107], v[192:207]
    ds_read_b64_tr_b16 v[116:117], v6 offset:46528
    ds_read_b64_tr_b16 v[118:119], v6 offset:47680
    v_mul_f32 v19, v187, v187
    v_fmaak_f32 v12, v10, v12, 0xc0135761
    v_fmaak_f32 v13, v10, v13, 0xc0135761
    v_fmaak_f32 v14, v10, v14, 0xc0135761
    v_fmaak_f32 v15, v10, v15, 0xc0135761
    v_fmaak_f32 v16, v10, v16, 0xc0135761
    v_fmaak_f32 v17, v10, v17, 0xc0135761
    s_waitcnt lgkmcnt(14)
    v_mfma_f32_32x32x16_bf16 v[192:207], v[136:139], v[108:111], v[192:207]
    ds_read_b64_tr_b16 v[120:121], v6 offset:51136
    ds_read_b64_tr_b16 v[122:123], v6 offset:52288
    v_fmaak_f32 v18, v10, v18, 0xc0135761
    v_fmaak_f32 v19, v10, v19, 0xc0135761
    v_mul_f32 v12, v12, v176
    v_mul_f32 v13, v13, v177
    v_mul_f32 v14, v14, v178
    v_mul_f32 v15, v15, v179
    v_mul_f32 v16, v16, v184
    s_waitcnt lgkmcnt(14)
    v_mfma_f32_32x32x16_bf16 v[192:207], v[140:143], v[48:51], v[192:207]
    ds_read_b64_tr_b16 v[124:125], v7 offset:192
    ds_read_b64_tr_b16 v[126:127], v7 offset:1344
    v_mul_f32 v17, v17, v185
    v_mul_f32 v18, v18, v186
    v_mul_f32 v19, v19, v187
    v_exp_f32 v12, v12
    v_mul_f32 v180, v176, v180
    v_exp_f32 v13, v13
    s_waitcnt lgkmcnt(14)
    v_mfma_f32_32x32x16_bf16 v[192:207], v[28:31], v[52:55], v[192:207]
    ds_read_b64_tr_b16 v[44:45], v7 offset:4800
    ds_read_b64_tr_b16 v[46:47], v7 offset:5952
    v_mul_f32 v181, v177, v181
    v_exp_f32 v14, v14
    v_mul_f32 v182, v178, v182
    v_exp_f32 v15, v15
    v_mul_f32 v183, v179, v183
    s_waitcnt lgkmcnt(14)
    v_mfma_f32_32x32x16_bf16 v[192:207], v[32:35], v[56:59], v[192:207]
    ds_read_b64_tr_b16 v[24:25], v7 offset:9408
    ds_read_b64_tr_b16 v[26:27], v7 offset:10560
    v_exp_f32 v16, v16
    v_mul_f32 v188, v184, v188
    v_exp_f32 v17, v17
    v_mul_f32 v189, v185, v189
    v_exp_f32 v18, v18
    s_waitcnt lgkmcnt(14)
    v_mfma_f32_32x32x16_bf16 v[192:207], v[36:39], v[60:63], v[192:207]
    ds_read_b64_tr_b16 v[128:129], v7 offset:14016
    ds_read_b64_tr_b16 v[130:131], v7 offset:15168
    v_mul_f32 v190, v186, v190
    v_exp_f32 v19, v19
    v_mul_f32 v191, v187, v191
    v_add_f32 v12, 1.0, v12
    v_add_f32 v13, 1.0, v13
    v_add_f32 v14, 1.0, v14
    s_waitcnt lgkmcnt(14)
    v_mfma_f32_32x32x16_bf16 v[208:223], v[40:43], v[64:67], v[208:223]
    ds_read_b64_tr_b16 v[132:133], v7 offset:37312
    ds_read_b64_tr_b16 v[134:135], v7 offset:38464
    v_add_f32 v15, 1.0, v15
    v_add_f32 v16, 1.0, v16
    v_add_f32 v17, 1.0, v17
    v_add_f32 v18, 1.0, v18
    v_add_f32 v19, 1.0, v19
    v_rcp_f32 v12, v12
    s_waitcnt lgkmcnt(14)
    v_mfma_f32_32x32x16_bf16 v[208:223], v[112:115], v[68:71], v[208:223]
    ds_read_b64_tr_b16 v[136:137], v7 offset:41920
    ds_read_b64_tr_b16 v[138:139], v7 offset:43072
    v_rcp_f32 v13, v13
    v_rcp_f32 v14, v14
    v_mul_f32 v12, v12, v180
    v_rcp_f32 v15, v15
    s_waitcnt lgkmcnt(14)
    v_mfma_f32_32x32x16_bf16 v[208:223], v[116:119], v[72:75], v[208:223]
    ds_read_b64_tr_b16 v[140:141], v7 offset:46528
    ds_read_b64_tr_b16 v[142:143], v7 offset:47680
    v_mul_f32 v13, v13, v181
    v_rcp_f32 v16, v16
    v_mul_f32 v14, v14, v182
    v_rcp_f32 v17, v17
    v_mul_f32 v15, v15, v183
    s_waitcnt lgkmcnt(14)
    v_mfma_f32_32x32x16_bf16 v[208:223], v[120:123], v[76:79], v[208:223]
    ds_read_b64_tr_b16 v[28:29], v7 offset:51136
    ds_read_b64_tr_b16 v[30:31], v7 offset:52288
    v_rcp_f32 v18, v18
    v_mul_f32 v16, v16, v188
    v_rcp_f32 v19, v19
    v_mul_f32 v17, v17, v189
    v_mul_f32 v18, v18, v190
    s_waitcnt lgkmcnt(14)
    v_mfma_f32_32x32x16_bf16 v[208:223], v[124:127], v[80:83], v[208:223]
    ds_read_b64_tr_b16 v[32:33], v6 offset:192
    ds_read_b64_tr_b16 v[34:35], v6 offset:1344
    v_mul_f32 v19, v19, v191
    v_cvt_pk_bf16_f32 v20, v12, v13
    v_cvt_pk_bf16_f32 v21, v14, v15
    v_cvt_pk_bf16_f32 v22, v16, v17
    v_cvt_pk_bf16_f32 v23, v18, v19
    buffer_store_dwordx4 v[20:23], v9, s[28:31], s37 offen sc1
    s_add_u32 s37, s37, 512
    s_add_u32 s95, s95, 1
    s_cmp_eq_u32 s95, 9
    s_cselect_b32 s94, 4608, 0
    s_sub_u32 s37, s37, s94
    s_waitcnt lgkmcnt(14)
    v_mfma_f32_32x32x16_bf16 v[208:223], v[44:47], v[84:87], v[208:223]
    ds_read_b64_tr_b16 v[36:37], v6 offset:4800
    ds_read_b64_tr_b16 v[38:39], v6 offset:5952
    v_mul_f32 v12, v192, v192
    v_mul_f32 v13, v193, v193
    v_mul_f32 v14, v194, v194
    v_mul_f32 v15, v195, v195
    v_mul_f32 v16, v200, v200
    v_mul_f32 v17, v201, v201
    v_mul_f32 v18, v202, v202
    s_waitcnt lgkmcnt(14)
    v_mfma_f32_32x32x16_bf16 v[208:223], v[24:27], v[88:91], v[208:223]
    ds_read_b64_tr_b16 v[40:41], v6 offset:9408
    ds_read_b64_tr_b16 v[42:43], v6 offset:10560
    v_mul_f32 v19, v203, v203
    v_fmaak_f32 v12, v10, v12, 0xc0135761
    v_fmaak_f32 v13, v10, v13, 0xc0135761
    v_fmaak_f32 v14, v10, v14, 0xc0135761
    v_fmaak_f32 v15, v10, v15, 0xc0135761
    v_fmaak_f32 v16, v10, v16, 0xc0135761
    v_fmaak_f32 v17, v10, v17, 0xc0135761
    s_waitcnt lgkmcnt(14)
    v_mfma_f32_32x32x16_bf16 v[208:223], v[128:131], v[92:95], v[208:223]
    ds_read_b64_tr_b16 v[112:113], v6 offset:14016
    ds_read_b64_tr_b16 v[114:115], v6 offset:15168
    v_fmaak_f32 v18, v10, v18, 0xc0135761
    v_fmaak_f32 v19, v10, v19, 0xc0135761
    v_mul_f32 v12, v12, v192
    v_mul_f32 v13, v13, v193
    v_mul_f32 v14, v14, v194
    v_mul_f32 v15, v15, v195
    v_mul_f32 v16, v16, v200
    s_waitcnt lgkmcnt(14)
    v_mfma_f32_32x32x16_bf16 v[208:223], v[132:135], v[96:99], v[208:223]
    ds_read_b64_tr_b16 v[116:117], v6 offset:37344
    ds_read_b64_tr_b16 v[118:119], v6 offset:38496
    v_mul_f32 v17, v17, v201
    v_mul_f32 v18, v18, v202
    v_mul_f32 v19, v19, v203
    v_exp_f32 v12, v12
    v_mul_f32 v196, v192, v196
    v_exp_f32 v13, v13
    s_waitcnt lgkmcnt(14)
    v_mfma_f32_32x32x16_bf16 v[208:223], v[136:139], v[100:103], v[208:223]
    ds_read_b64_tr_b16 v[120:121], v6 offset:41952
    ds_read_b64_tr_b16 v[122:123], v6 offset:43104
    v_mul_f32 v197, v193, v197
    v_exp_f32 v14, v14
    v_mul_f32 v198, v194, v198
    v_exp_f32 v15, v15
    v_mul_f32 v199, v195, v199
    s_waitcnt lgkmcnt(14)
    v_mfma_f32_32x32x16_bf16 v[208:223], v[140:143], v[104:107], v[208:223]
    ds_read_b64_tr_b16 v[124:125], v6 offset:46560
    ds_read_b64_tr_b16 v[126:127], v6 offset:47712
    v_exp_f32 v16, v16
    v_mul_f32 v204, v200, v204
    v_exp_f32 v17, v17
    v_mul_f32 v205, v201, v205
    v_exp_f32 v18, v18
    s_waitcnt lgkmcnt(14)
    v_mfma_f32_32x32x16_bf16 v[208:223], v[28:31], v[108:111], v[208:223]
    ds_read_b64_tr_b16 v[44:45], v6 offset:51168
    ds_read_b64_tr_b16 v[46:47], v6 offset:52320
    v_mul_f32 v206, v202, v206
    v_exp_f32 v19, v19
    v_mul_f32 v207, v203, v207
    v_add_f32 v12, 1.0, v12
    v_add_f32 v13, 1.0, v13
    v_add_f32 v14, 1.0, v14
    s_waitcnt lgkmcnt(14)
    v_mfma_f32_32x32x16_bf16 v[208:223], v[32:35], v[48:51], v[208:223]
    ds_read_b64_tr_b16 v[24:25], v7 offset:224
    ds_read_b64_tr_b16 v[26:27], v7 offset:1376
    v_add_f32 v15, 1.0, v15
    v_add_f32 v16, 1.0, v16
    v_add_f32 v17, 1.0, v17
    v_add_f32 v18, 1.0, v18
    v_add_f32 v19, 1.0, v19
    v_rcp_f32 v12, v12
    s_waitcnt lgkmcnt(14)
    v_mfma_f32_32x32x16_bf16 v[208:223], v[36:39], v[52:55], v[208:223]
    ds_read_b64_tr_b16 v[128:129], v7 offset:4832
    ds_read_b64_tr_b16 v[130:131], v7 offset:5984
    v_rcp_f32 v13, v13
    v_rcp_f32 v14, v14
    v_mul_f32 v12, v12, v196
    v_rcp_f32 v15, v15
    s_waitcnt lgkmcnt(14)
    v_mfma_f32_32x32x16_bf16 v[208:223], v[40:43], v[56:59], v[208:223]
    ds_read_b64_tr_b16 v[132:133], v7 offset:9440
    ds_read_b64_tr_b16 v[134:135], v7 offset:10592
    v_mul_f32 v13, v13, v197
    v_rcp_f32 v16, v16
    v_mul_f32 v14, v14, v198
    v_rcp_f32 v17, v17
    v_mul_f32 v15, v15, v199
    s_waitcnt lgkmcnt(14)
    v_mfma_f32_32x32x16_bf16 v[208:223], v[112:115], v[60:63], v[208:223]
    ds_read_b64_tr_b16 v[136:137], v7 offset:14048
    ds_read_b64_tr_b16 v[138:139], v7 offset:15200
    v_rcp_f32 v18, v18
    v_mul_f32 v16, v16, v204
    v_rcp_f32 v19, v19
    v_mul_f32 v17, v17, v205
    v_mul_f32 v18, v18, v206
    s_waitcnt lgkmcnt(14)
    v_mfma_f32_32x32x16_bf16 v[224:239], v[116:119], v[64:67], v[224:239]
    ds_read_b64_tr_b16 v[140:141], v7 offset:37344
    ds_read_b64_tr_b16 v[142:143], v7 offset:38496
    v_mul_f32 v19, v19, v207
    v_cvt_pk_bf16_f32 v20, v12, v13
    v_cvt_pk_bf16_f32 v21, v14, v15
    v_cvt_pk_bf16_f32 v22, v16, v17
    v_cvt_pk_bf16_f32 v23, v18, v19
    buffer_store_dwordx4 v[20:23], v9, s[28:31], s37 offen sc1
    s_add_u32 s37, s37, 512
    s_add_u32 s95, s95, 1
    s_cmp_eq_u32 s95, 9
    s_cselect_b32 s94, 4608, 0
    s_sub_u32 s37, s37, s94
    s_waitcnt lgkmcnt(14)
    v_mfma_f32_32x32x16_bf16 v[224:239], v[120:123], v[68:71], v[224:239]
    ds_read_b64_tr_b16 v[28:29], v7 offset:41952
    ds_read_b64_tr_b16 v[30:31], v7 offset:43104
    v_mul_f32 v12, v208, v208
    v_mul_f32 v13, v209, v209
    v_mul_f32 v14, v210, v210
    v_mul_f32 v15, v211, v211
    v_mul_f32 v16, v216, v216
    v_mul_f32 v17, v217, v217
    v_mul_f32 v18, v218, v218
    s_waitcnt lgkmcnt(14)
    v_mfma_f32_32x32x16_bf16 v[224:239], v[124:127], v[72:75], v[224:239]
    ds_read_b64_tr_b16 v[32:33], v7 offset:46560
    ds_read_b64_tr_b16 v[34:35], v7 offset:47712
    v_mul_f32 v19, v219, v219
    v_fmaak_f32 v12, v10, v12, 0xc0135761
    v_fmaak_f32 v13, v10, v13, 0xc0135761
    v_fmaak_f32 v14, v10, v14, 0xc0135761
    v_fmaak_f32 v15, v10, v15, 0xc0135761
    v_fmaak_f32 v16, v10, v16, 0xc0135761
    v_fmaak_f32 v17, v10, v17, 0xc0135761
    s_waitcnt lgkmcnt(14)
    v_mfma_f32_32x32x16_bf16 v[224:239], v[44:47], v[76:79], v[224:239]
    ds_read_b64_tr_b16 v[36:37], v7 offset:51168
    ds_read_b64_tr_b16 v[38:39], v7 offset:52320
    v_fmaak_f32 v18, v10, v18, 0xc0135761
    v_fmaak_f32 v19, v10, v19, 0xc0135761
    v_mul_f32 v12, v12, v208
    v_mul_f32 v13, v13, v209
    v_mul_f32 v14, v14, v210
    v_mul_f32 v15, v15, v211
    v_mul_f32 v16, v16, v216
    s_waitcnt lgkmcnt(14)
    v_mfma_f32_32x32x16_bf16 v[224:239], v[24:27], v[80:83], v[224:239]
    ds_read_b64_tr_b16 v[40:41], v6 offset:224
    ds_read_b64_tr_b16 v[42:43], v6 offset:1376
    v_mul_f32 v17, v17, v217
    v_mul_f32 v18, v18, v218
    v_mul_f32 v19, v19, v219
    v_exp_f32 v12, v12
    v_mul_f32 v212, v208, v212
    v_exp_f32 v13, v13
    s_waitcnt lgkmcnt(14)
    v_mfma_f32_32x32x16_bf16 v[224:239], v[128:131], v[84:87], v[224:239]
    ds_read_b64_tr_b16 v[112:113], v6 offset:4832
    ds_read_b64_tr_b16 v[114:115], v6 offset:5984
    v_mul_f32 v213, v209, v213
    v_exp_f32 v14, v14
    v_mul_f32 v214, v210, v214
    v_exp_f32 v15, v15
    v_mul_f32 v215, v211, v215
    s_waitcnt lgkmcnt(14)
    v_mfma_f32_32x32x16_bf16 v[224:239], v[132:135], v[88:91], v[224:239]
    ds_read_b64_tr_b16 v[116:117], v6 offset:9440
    ds_read_b64_tr_b16 v[118:119], v6 offset:10592
    v_exp_f32 v16, v16
    v_mul_f32 v220, v216, v220
    v_exp_f32 v17, v17
    v_mul_f32 v221, v217, v221
    v_exp_f32 v18, v18
    s_waitcnt lgkmcnt(14)
    v_mfma_f32_32x32x16_bf16 v[224:239], v[136:139], v[92:95], v[224:239]
    ds_read_b64_tr_b16 v[120:121], v6 offset:14048
    ds_read_b64_tr_b16 v[122:123], v6 offset:15200
    v_mul_f32 v222, v218, v222
    v_exp_f32 v19, v19
    v_mul_f32 v223, v219, v223
    v_add_f32 v12, 1.0, v12
    v_add_f32 v13, 1.0, v13
    v_add_f32 v14, 1.0, v14
    s_waitcnt lgkmcnt(14)
    v_mfma_f32_32x32x16_bf16 v[224:239], v[140:143], v[96:99], v[224:239]
    ds_read_b64_tr_b16 v[124:125], v6 offset:37376
    ds_read_b64_tr_b16 v[126:127], v6 offset:38528
    v_add_f32 v15, 1.0, v15
    v_add_f32 v16, 1.0, v16
    v_add_f32 v17, 1.0, v17
    v_add_f32 v18, 1.0, v18
    v_add_f32 v19, 1.0, v19
    v_rcp_f32 v12, v12
    s_waitcnt lgkmcnt(14)
    v_mfma_f32_32x32x16_bf16 v[224:239], v[28:31], v[100:103], v[224:239]
    ds_read_b64_tr_b16 v[44:45], v6 offset:41984
    ds_read_b64_tr_b16 v[46:47], v6 offset:43136
    v_rcp_f32 v13, v13
    v_rcp_f32 v14, v14
    v_mul_f32 v12, v12, v212
    v_rcp_f32 v15, v15
    s_waitcnt lgkmcnt(14)
    v_mfma_f32_32x32x16_bf16 v[224:239], v[32:35], v[104:107], v[224:239]
    ds_read_b64_tr_b16 v[24:25], v6 offset:46592
    ds_read_b64_tr_b16 v[26:27], v6 offset:47744
    v_mul_f32 v13, v13, v213
    v_rcp_f32 v16, v16
    v_mul_f32 v14, v14, v214
    v_rcp_f32 v17, v17
    v_mul_f32 v15, v15, v215
    s_waitcnt lgkmcnt(14)
    v_mfma_f32_32x32x16_bf16 v[224:239], v[36:39], v[108:111], v[224:239]
    ds_read_b64_tr_b16 v[128:129], v6 offset:51200
    ds_read_b64_tr_b16 v[130:131], v6 offset:52352
    v_rcp_f32 v18, v18
    v_mul_f32 v16, v16, v220
    v_rcp_f32 v19, v19
    v_mul_f32 v17, v17, v221
    v_mul_f32 v18, v18, v222
    s_waitcnt lgkmcnt(14)
    v_mfma_f32_32x32x16_bf16 v[224:239], v[40:43], v[48:51], v[224:239]
    ds_read_b64_tr_b16 v[132:133], v7 offset:256
    ds_read_b64_tr_b16 v[134:135], v7 offset:1408
    v_mul_f32 v19, v19, v223
    v_cvt_pk_bf16_f32 v20, v12, v13
    v_cvt_pk_bf16_f32 v21, v14, v15
    v_cvt_pk_bf16_f32 v22, v16, v17
    v_cvt_pk_bf16_f32 v23, v18, v19
    buffer_store_dwordx4 v[20:23], v9, s[28:31], s37 offen sc1
    s_add_u32 s37, s37, 512
    s_add_u32 s95, s95, 1
    s_cmp_eq_u32 s95, 9
    s_cselect_b32 s94, 4608, 0
    s_sub_u32 s37, s37, s94
    s_waitcnt vmcnt(2)
    s_add_u32 s59, s93, 0
    s_mov_b64 exec, 1
    buffer_atomic_add v4, v3, s[52:55], s59 offen sc1
    s_cmp_eq_u32 s92, s93
    s_cbranch_scc1 G2_sgA
    s_add_u32 s59, s92, 0
    buffer_atomic_add v4, v3, s[52:55], s59 offen sc1
G2_sgA:
    s_mov_b64 exec, -1
    s_waitcnt lgkmcnt(14)
    v_mfma_f32_32x32x16_bf16 v[224:239], v[112:115], v[52:55], v[224:239]
    ds_read_b64_tr_b16 v[136:137], v7 offset:4864
    ds_read_b64_tr_b16 v[138:139], v7 offset:6016
    s_waitcnt lgkmcnt(14)
    v_mfma_f32_32x32x16_bf16 v[224:239], v[116:119], v[56:59], v[224:239]
    ds_read_b64_tr_b16 v[140:141], v7 offset:9472
    ds_read_b64_tr_b16 v[142:143], v7 offset:10624
    s_waitcnt lgkmcnt(14)
    v_mfma_f32_32x32x16_bf16 v[224:239], v[120:123], v[60:63], v[224:239]
    ds_read_b64_tr_b16 v[28:29], v7 offset:14080
    ds_read_b64_tr_b16 v[30:31], v7 offset:15232
    s_waitcnt lgkmcnt(14)
    v_mfma_f32_32x32x16_bf16 v[240:255], v[124:127], v[64:67], v[240:255]
    ds_read_b64_tr_b16 v[32:33], v7 offset:37376
    ds_read_b64_tr_b16 v[34:35], v7 offset:38528
    s_waitcnt lgkmcnt(14)
    v_mfma_f32_32x32x16_bf16 v[240:255], v[44:47], v[68:71], v[240:255]
    ds_read_b64_tr_b16 v[36:37], v7 offset:41984
    ds_read_b64_tr_b16 v[38:39], v7 offset:43136
    s_nop 1
    v_mul_f32 v12, v224, v224
    v_mul_f32 v13, v225, v225
    v_mul_f32 v14, v226, v226
    v_mul_f32 v15, v227, v227
    v_mul_f32 v16, v232, v232
    v_mul_f32 v17, v233, v233
    v_mul_f32 v18, v234, v234
    s_waitcnt lgkmcnt(14)
    v_mfma_f32_32x32x16_bf16 v[240:255], v[24:27], v[72:75], v[240:255]
    ds_read_b64_tr_b16 v[40:41], v7 offset:46592
    ds_read_b64_tr_b16 v[42:43], v7 offset:47744
    v_mul_f32 v19, v235, v235
    v_fmaak_f32 v12, v10, v12, 0xc0135761
    v_fmaak_f32 v13, v10, v13, 0xc0135761
    v_fmaak_f32 v14, v10, v14, 0xc0135761
    v_fmaak_f32 v15, v10, v15, 0xc0135761
    v_fmaak_f32 v16, v10, v16, 0xc0135761
    v_fmaak_f32 v17, v10, v17, 0xc0135761
    s_waitcnt lgkmcnt(14)
    v_mfma_f32_32x32x16_bf16 v[240:255], v[128:131], v[76:79], v[240:255]
    ds_read_b64_tr_b16 v[112:113], v7 offset:51200
    ds_read_b64_tr_b16 v[114:115], v7 offset:52352
    v_fmaak_f32 v18, v10, v18, 0xc0135761
    v_fmaak_f32 v19, v10, v19, 0xc0135761
    v_mul_f32 v12, v12, v224
    v_mul_f32 v13, v13, v225
    v_mul_f32 v14, v14, v226
    v_mul_f32 v15, v15, v227
    v_mul_f32 v16, v16, v232
    s_waitcnt lgkmcnt(14)
    v_mfma_f32_32x32x16_bf16 v[240:255], v[132:135], v[80:83], v[240:255]
    ds_read_b64_tr_b16 v[116:117], v6 offset:256
    ds_read_b64_tr_b16 v[118:119], v6 offset:1408
    v_mul_f32 v17, v17, v233
    v_mul_f32 v18, v18, v234
    v_mul_f32 v19, v19, v235
    v_exp_f32 v12, v12
    v_mul_f32 v228, v224, v228
    v_exp_f32 v13, v13
    s_waitcnt lgkmcnt(14)
    v_mfma_f32_32x32x16_bf16 v[240:255], v[136:139], v[84:87], v[240:255]
    ds_read_b64_tr_b16 v[120:121], v6 offset:4864
    ds_read_b64_tr_b16 v[122:123], v6 offset:6016
    v_mul_f32 v229, v225, v229
    v_exp_f32 v14, v14
    v_mul_f32 v230, v226, v230
    v_exp_f32 v15, v15
    v_mul_f32 v231, v227, v231
    s_waitcnt lgkmcnt(14)
    v_mfma_f32_32x32x16_bf16 v[240:255], v[140:143], v[88:91], v[240:255]
    ds_read_b64_tr_b16 v[124:125], v6 offset:9472
    ds_read_b64_tr_b16 v[126:127], v6 offset:10624
    v_exp_f32 v16, v16
    v_mul_f32 v236, v232, v236
    v_exp_f32 v17, v17
    v_mul_f32 v237, v233, v237
    v_exp_f32 v18, v18
    s_waitcnt lgkmcnt(14)
    v_mfma_f32_32x32x16_bf16 v[240:255], v[28:31], v[92:95], v[240:255]
    ds_read_b64_tr_b16 v[44:45], v6 offset:14080
    ds_read_b64_tr_b16 v[46:47], v6 offset:15232
    v_mul_f32 v238, v234, v238
    v_exp_f32 v19, v19
    v_mul_f32 v239, v235, v239
    v_add_f32 v12, 1.0, v12
    v_add_f32 v13, 1.0, v13
    v_add_f32 v14, 1.0, v14
    s_waitcnt lgkmcnt(14)
    v_mfma_f32_32x32x16_bf16 v[240:255], v[32:35], v[96:99], v[240:255]
    v_add_f32 v15, 1.0, v15
    v_add_f32 v16, 1.0, v16
    v_add_f32 v17, 1.0, v17
    v_add_f32 v18, 1.0, v18
    v_add_f32 v19, 1.0, v19
    v_rcp_f32 v12, v12
    s_waitcnt lgkmcnt(12)
    v_mfma_f32_32x32x16_bf16 v[240:255], v[36:39], v[100:103], v[240:255]
    v_rcp_f32 v13, v13
    v_rcp_f32 v14, v14
    v_mul_f32 v12, v12, v228
    v_rcp_f32 v15, v15
    s_waitcnt lgkmcnt(10)
    v_mfma_f32_32x32x16_bf16 v[240:255], v[40:43], v[104:107], v[240:255]
    v_mul_f32 v13, v13, v229
    v_rcp_f32 v16, v16
    v_mul_f32 v14, v14, v230
    v_rcp_f32 v17, v17
    v_mul_f32 v15, v15, v231
    s_waitcnt lgkmcnt(8)
    v_mfma_f32_32x32x16_bf16 v[240:255], v[112:115], v[108:111], v[240:255]
    v_rcp_f32 v18, v18
    v_mul_f32 v16, v16, v236
    v_rcp_f32 v19, v19
    v_mul_f32 v17, v17, v237
    v_mul_f32 v18, v18, v238
    s_waitcnt lgkmcnt(6)
    v_mfma_f32_32x32x16_bf16 v[240:255], v[116:119], v[48:51], v[240:255]
    v_mul_f32 v19, v19, v239
    v_cvt_pk_bf16_f32 v20, v12, v13
    v_cvt_pk_bf16_f32 v21, v14, v15
    v_cvt_pk_bf16_f32 v22, v16, v17
    v_cvt_pk_bf16_f32 v23, v18, v19
    buffer_store_dwordx4 v[20:23], v9, s[28:31], s37 offen sc1
    s_add_u32 s37, s37, 512
    s_add_u32 s95, s95, 1
    s_cmp_eq_u32 s95, 9
    s_cselect_b32 s94, 4608, 0
    s_sub_u32 s37, s37, s94
    s_cmp_lg_u32 s3, 4
    s_cbranch_scc1 G2_ep
    s_add_u32 s59, s91, 0
    s_mov_b32 exec_lo, s90
    s_mov_b32 exec_hi, 0
    buffer_load_dword v5, v2, s[52:55], s59 offen sc1
    s_mov_b64 exec, -1
G2_ep:
    s_waitcnt lgkmcnt(4)
    v_mfma_f32_32x32x16_bf16 v[240:255], v[120:123], v[52:55], v[240:255]
    s_waitcnt lgkmcnt(2)
    v_mfma_f32_32x32x16_bf16 v[240:255], v[124:127], v[56:59], v[240:255]
    s_waitcnt lgkmcnt(0)
    v_mfma_f32_32x32x16_bf16 v[240:255], v[44:47], v[60:63], v[240:255]
    s_nop 11
    v_mul_f32 v12, v240, v240
    v_mul_f32 v13, v241, v241
    v_mul_f32 v14, v242, v242
    v_mul_f32 v15, v243, v243
    v_mul_f32 v16, v248, v248
    v_mul_f32 v17, v249, v249
    v_mul_f32 v18, v250, v250
    v_mul_f32 v19, v251, v251
    v_fmaak_f32 v12, v10, v12, 0xc0135761
    v_fmaak_f32 v13, v10, v13, 0xc0135761
    v_fmaak_f32 v14, v10, v14, 0xc0135761
    v_fmaak_f32 v15, v10, v15, 0xc0135761
    v_fmaak_f32 v16, v10, v16, 0xc0135761
    v_fmaak_f32 v17, v10, v17, 0xc0135761
    v_fmaak_f32 v18, v10, v18, 0xc0135761
    v_fmaak_f32 v19, v10, v19, 0xc0135761
    v_mul_f32 v12, v12, v240
    v_mul_f32 v13, v13, v241
    v_mul_f32 v14, v14, v242
    v_mul_f32 v15, v15, v243
    v_mul_f32 v16, v16, v248
    v_mul_f32 v17, v17, v249
    v_mul_f32 v18, v18, v250
    v_mul_f32 v19, v19, v251
    v_exp_f32 v12, v12
    v_mul_f32 v244, v240, v244
    v_exp_f32 v13, v13
    v_mul_f32 v245, v241, v245
    v_exp_f32 v14, v14
    v_mul_f32 v246, v242, v246
    v_exp_f32 v15, v15
    v_mul_f32 v247, v243, v247
    v_exp_f32 v16, v16
    v_mul_f32 v252, v248, v252
    v_exp_f32 v17, v17
    v_mul_f32 v253, v249, v253
    v_exp_f32 v18, v18
    v_mul_f32 v254, v250, v254
    v_exp_f32 v19, v19
    v_mul_f32 v255, v251, v255
    v_add_f32 v12, 1.0, v12
    v_add_f32 v13, 1.0, v13
    v_add_f32 v14, 1.0, v14
    v_add_f32 v15, 1.0, v15
    v_add_f32 v16, 1.0, v16
    v_add_f32 v17, 1.0, v17
    v_add_f32 v18, 1.0, v18
    v_add_f32 v19, 1.0, v19
    v_rcp_f32 v12, v12
    v_rcp_f32 v13, v13
    v_rcp_f32 v14, v14
    v_mul_f32 v12, v12, v244
    v_rcp_f32 v15, v15
    v_mul_f32 v13, v13, v245
    v_rcp_f32 v16, v16
    v_mul_f32 v14, v14, v246
    v_rcp_f32 v17, v17
    v_mul_f32 v15, v15, v247
    v_rcp_f32 v18, v18
    v_mul_f32 v16, v16, v252
    v_rcp_f32 v19, v19
    v_mul_f32 v17, v17, v253
    v_mul_f32 v18, v18, v254
    v_mul_f32 v19, v19, v255
    v_cvt_pk_bf16_f32 v20, v12, v13
    v_cvt_pk_bf16_f32 v21, v14, v15
    v_cvt_pk_bf16_f32 v22, v16, v17
    v_cvt_pk_bf16_f32 v23, v18, v19
    buffer_store_dwordx4 v[20:23], v9, s[28:31], s37 offen sc1
    s_add_u32 s37, s37, 512
    s_add_u32 s95, s95, 1
    s_cmp_eq_u32 s95, 9
    s_cselect_b32 s94, 4608, 0
    s_sub_u32 s37, s37, s94
    s_setprio 0
    s_barrier
    s_cmp_lt_u32 s2, 234
    s_cbranch_scc1 G2_work
    s_waitcnt vmcnt(0)
    s_barrier
    s_cmp_lg_u32 s3, 1
    s_cbranch_scc1 G2_end
    s_lshl_b32 s59, s3, 6
    s_sub_u32 s58, s93, s59
    s_add_u32 s58, s58, 12288
    s_mov_b64 exec, 0xff
    buffer_atomic_add v4, v2, s[52:55], s58 offen sc1
    s_cmp_eq_u32 s92, s93
    s_cbranch_scc1 G2_sex
    s_sub_u32 s58, s92, s59
    s_add_u32 s58, s58, 12288
    buffer_atomic_add v4, v2, s[52:55], s58 offen sc1
G2_sex:
    s_mov_b64 exec, 1
    buffer_atomic_add v4, v3, s[52:55], s39 offen sc1
    s_mov_b64 exec, -1
    s_branch G2_end
G2_work:
    s_cmp_ge_u32 s3, 4
    s_cbranch_scc1 G2_loader
    v_lshrrev_b32 v10, 4, v0
    v_bfe_u32 v11, v0, 2, 2
    v_lshl_add_u32 v10, v10, 3, v11
    v_mul_u32_u24 v10, 384, v10
    v_and_b32 v11, 3, v0
    v_lshl_add_u32 v10, v11, 3, v10
    v_bfe_u32 v11, v0, 3, 2
    v_lshlrev_b32 v11, 5, v11
    s_lshl_b32 s36, s13, 5
    s_add_u32 s38, s17, 1
    s_sub_u32 s37, s38, 3
    s_min_u32 s38, s38, s37
    s_sub_u32 s37, s38, 3
    s_min_u32 s38, s38, s37
    s_mov_b32 s32, s38
    s_lshl_b32 s38, s38, 7
    s_add_u32 s38, s38, s36
    v_xor_b32 v14, s38, v11
    v_add_u32 v16, v10, v14
    v_add_u32 v148, 69632, v16
    s_add_u32 s38, s17, 2
    s_sub_u32 s37, s38, 3
    s_min_u32 s38, s38, s37
    s_sub_u32 s37, s38, 3
    s_min_u32 s38, s38, s37
    s_mov_b32 s33, s38
    s_lshl_b32 s38, s38, 7
    s_add_u32 s38, s38, s36
    v_xor_b32 v14, s38, v11
    v_add_u32 v17, v10, v14
    v_add_u32 v149, 69632, v17
    s_add_u32 s38, s17, 3
    s_sub_u32 s37, s38, 3
    s_min_u32 s38, s38, s37
    s_sub_u32 s37, s38, 3
    s_min_u32 s38, s38, s37
    s_mov_b32 s34, s38
    s_lshl_b32 s38, s38, 7
    s_add_u32 s38, s38, s36
    v_xor_b32 v14, s38, v11
    v_add_u32 v18, v10, v14
    v_add_u32 v150, 69632, v18
    v_lshlrev_b32 v19, 4, v0
    v_add_u32 v19, 24576, v19
    v_add_u32 v151, 69632, v19
    s_add_u32 s24, s10, 50331648
    s_addc_u32 s25, s11, 0
    s_mov_b32 s26, 9584640
    s_mov_b32 s27, 0x00020000
    s_mov_b32 s4, s46
    s_mov_b32 s5, s47
    s_mov_b32 s6, 2359296
    s_mov_b32 s7, 0x00020000
    v_lshlrev_b32 v10, 4, v0
    v_lshlrev_b32 v9, 3, v0
    s_mul_i32 s35, s18, 61440
    s_mul_i32 s37, s3, 5120
    s_add_u32 s35, s35, s37
    s_cmp_lt_u32 s17, s32
    s_cselect_b32 s37, 0, 1
    s_sub_u32 s37, s17, s37
    s_mul_i32 s37, s37, 2560
    s_mul_i32 s38, s32, 20480
    s_add_u32 s37, s37, s38
    s_add_u32 s32, s37, s35
    s_cmp_lt_u32 s17, s33
    s_cselect_b32 s37, 0, 1
    s_sub_u32 s37, s17, s37
    s_mul_i32 s37, s37, 2560
    s_mul_i32 s38, s33, 20480
    s_add_u32 s37, s37, s38
    s_add_u32 s33, s37, s35
    s_mul_i32 s37, s17, 20480
    s_add_u32 s35, s35, s37
    s_add_u32 s34, s35, 2560
    v_and_b32 v11, 15, v0
    s_mul_i32 s37, s15, 80
    v_add_u32 v11, s37, v11
    s_movk_i32 s38, 1152
    v_mul_u32_u24 v11, s38, v11
    v_lshrrev_b32 v12, 4, v0
    v_lshl_add_u32 v11, v12, 3, v11
    s_mul_i32 s37, s16, 384
    s_lshl_b32 s38, s3, 5
    s_add_u32 s37, s37, s38
    s_lshl_b32 s38, s17, 7
    s_add_u32 s37, s37, s38
    v_add_u32 v11, s37, v11
    v_mov_b32 v64, 0
    v_mov_b32 v65, 0
    v_mov_b32 v66, 0
    v_mov_b32 v67, 0
    v_mov_b32 v68, 0
    v_mov_b32 v69, 0
    v_mov_b32 v70, 0
    v_mov_b32 v71, 0
    v_mov_b32 v72, 0
    v_mov_b32 v73, 0
    v_mov_b32 v74, 0
    v_mov_b32 v75, 0
    v_mov_b32 v76, 0
    v_mov_b32 v77, 0
    v_mov_b32 v78, 0
    v_mov_b32 v79, 0
    v_mov_b32 v80, 0
    v_mov_b32 v81, 0
    v_mov_b32 v82, 0
    v_mov_b32 v83, 0
    v_mov_b32 v84, 0
    v_mov_b32 v85, 0
    v_mov_b32 v86, 0
    v_mov_b32 v87, 0
    v_mov_b32 v88, 0
    v_mov_b32 v89, 0
    v_mov_b32 v90, 0
    v_mov_b32 v91, 0
    v_mov_b32 v92, 0
    v_mov_b32 v93, 0
    v_mov_b32 v94, 0
    v_mov_b32 v95, 0
    v_mov_b32 v96, 0
    v_mov_b32 v97, 0
    v_mov_b32 v98, 0
    v_mov_b32 v99, 0
    v_mov_b32 v100, 0
    v_mov_b32 v101, 0
    v_mov_b32 v102, 0
    v_mov_b32 v103, 0
    v_mov_b32 v104, 0
    v_mov_b32 v105, 0
    v_mov_b32 v106, 0
    v_mov_b32 v107, 0
    v_mov_b32 v108, 0
    v_mov_b32 v109, 0
    v_mov_b32 v110, 0
    v_mov_b32 v111, 0
    v_mov_b32 v112, 0
    v_mov_b32 v113, 0
    v_mov_b32 v114, 0
    v_mov_b32 v115, 0
    v_mov_b32 v116, 0
    v_mov_b32 v117, 0
    v_mov_b32 v118, 0
    v_mov_b32 v119, 0
    v_mov_b32 v120, 0
    v_mov_b32 v121, 0
    v_mov_b32 v122, 0
    v_mov_b32 v123, 0
    s_barrier
    s_waitcnt vmcnt(0)
    s_mov_b32 s40, 0
G2_cloop:
    s_barrier
    s_lshl_b32 s59, s3, 3
    s_add_u32 s59, s59, s40
    s_cmp_lg_u32 s59, 8
    s_cbranch_scc1 G2_ns
    s_lshl_b32 s59, s3, 6
    s_sub_u32 s58, s93, s59
    s_add_u32 s58, s58, 12288
    s_mov_b64 exec, 0xff
    buffer_atomic_add v4, v2, s[52:55], s58 offen sc1
    s_cmp_eq_u32 s92, s93
    s_cbranch_scc1 G2_sec
    s_sub_u32 s58, s92, s59
    s_add_u32 s58, s58, 12288
    buffer_atomic_add v4, v2, s[52:55], s58 offen sc1
G2_sec:
    s_mov_b64 exec, 1
    buffer_atomic_add v4, v3, s[52:55], s39 offen sc1
    s_mov_b64 exec, -1
G2_ns:
    ds_read_b64_tr_b16 v[124:125], v16 offset:0
    ds_read_b64_tr_b16 v[126:127], v16 offset:1536
    ds_read_b64_tr_b16 v[128:129], v17 offset:0
    ds_read_b64_tr_b16 v[130:131], v17 offset:1536
    ds_read_b64_tr_b16 v[132:133], v18 offset:0
    ds_read_b64_tr_b16 v[134:135], v18 offset:1536
    ds_read_b128 v[24:27], v19 offset:0
    ds_read_b128 v[32:35], v19 offset:2048
    ds_read_b128 v[40:43], v19 offset:4096
    ds_read_b128 v[48:51], v19 offset:6144
    ds_read_b128 v[56:59], v19 offset:8192
    s_waitcnt lgkmcnt(4)
    v_mfma_f32_16x16x32_bf16 v[64:67], v[124:127], v[24:27], v[64:67]
    ds_read_b64_tr_b16 v[136:137], v16 offset:12288
    ds_read_b64_tr_b16 v[138:139], v16 offset:13824
    v_mfma_f32_16x16x32_bf16 v[84:87], v[128:131], v[24:27], v[84:87]
    ds_read_b64_tr_b16 v[140:141], v17 offset:12288
    ds_read_b64_tr_b16 v[142:143], v17 offset:13824
    v_mfma_f32_16x16x32_bf16 v[104:107], v[132:135], v[24:27], v[104:107]
    ds_read_b64_tr_b16 v[144:145], v18 offset:12288
    ds_read_b64_tr_b16 v[146:147], v18 offset:13824
    s_waitcnt lgkmcnt(9)
    v_mfma_f32_16x16x32_bf16 v[68:71], v[124:127], v[32:35], v[68:71]
    ds_read_b128 v[28:31], v19 offset:1024
    v_mfma_f32_16x16x32_bf16 v[88:91], v[128:131], v[32:35], v[88:91]
    ds_read_b128 v[36:39], v19 offset:3072
    v_mfma_f32_16x16x32_bf16 v[108:111], v[132:135], v[32:35], v[108:111]
    ds_read_b128 v[44:47], v19 offset:5120
    s_waitcnt lgkmcnt(11)
    v_mfma_f32_16x16x32_bf16 v[72:75], v[124:127], v[40:43], v[72:75]
    ds_read_b128 v[52:55], v19 offset:7168
    v_mfma_f32_16x16x32_bf16 v[92:95], v[128:131], v[40:43], v[92:95]
    ds_read_b128 v[60:63], v19 offset:9216
    v_mfma_f32_16x16x32_bf16 v[112:115], v[132:135], v[40:43], v[112:115]
    s_waitcnt lgkmcnt(12)
    v_mfma_f32_16x16x32_bf16 v[76:79], v[124:127], v[48:51], v[76:79]
    v_mfma_f32_16x16x32_bf16 v[96:99], v[128:131], v[48:51], v[96:99]
    v_mfma_f32_16x16x32_bf16 v[116:119], v[132:135], v[48:51], v[116:119]
    s_waitcnt lgkmcnt(11)
    v_mfma_f32_16x16x32_bf16 v[80:83], v[124:127], v[56:59], v[80:83]
    v_mfma_f32_16x16x32_bf16 v[100:103], v[128:131], v[56:59], v[100:103]
    v_mfma_f32_16x16x32_bf16 v[120:123], v[132:135], v[56:59], v[120:123]
    s_waitcnt lgkmcnt(4)
    v_mfma_f32_16x16x32_bf16 v[64:67], v[136:139], v[28:31], v[64:67]
    v_mfma_f32_16x16x32_bf16 v[84:87], v[140:143], v[28:31], v[84:87]
    v_mfma_f32_16x16x32_bf16 v[104:107], v[144:147], v[28:31], v[104:107]
    s_waitcnt lgkmcnt(3)
    v_mfma_f32_16x16x32_bf16 v[68:71], v[136:139], v[36:39], v[68:71]
    v_mfma_f32_16x16x32_bf16 v[88:91], v[140:143], v[36:39], v[88:91]
    v_mfma_f32_16x16x32_bf16 v[108:111], v[144:147], v[36:39], v[108:111]
    s_waitcnt lgkmcnt(2)
    v_mfma_f32_16x16x32_bf16 v[72:75], v[136:139], v[44:47], v[72:75]
    v_mfma_f32_16x16x32_bf16 v[92:95], v[140:143], v[44:47], v[92:95]
    v_mfma_f32_16x16x32_bf16 v[112:115], v[144:147], v[44:47], v[112:115]
    s_waitcnt lgkmcnt(1)
    v_mfma_f32_16x16x32_bf16 v[76:79], v[136:139], v[52:55], v[76:79]
    v_mfma_f32_16x16x32_bf16 v[96:99], v[140:143], v[52:55], v[96:99]
    v_mfma_f32_16x16x32_bf16 v[116:119], v[144:147], v[52:55], v[116:119]
    s_waitcnt lgkmcnt(0)
    v_mfma_f32_16x16x32_bf16 v[80:83], v[136:139], v[60:63], v[80:83]
    v_mfma_f32_16x16x32_bf16 v[100:103], v[140:143], v[60:63], v[100:103]
    v_mfma_f32_16x16x32_bf16 v[120:123], v[144:147], v[60:63], v[120:123]
    s_lshl_b32 s59, s3, 3
    s_add_u32 s59, s59, s40
    s_cmp_lg_u32 s59, 2
    s_cbranch_scc1 G2_nb0
    s_waitcnt vmcnt(0)
    s_mov_b32 s58, 0
G2_pcB:
    v_cmp_gt_u32 vcc, s89, v5
    s_add_u32 s58, s58, 1
    s_nop 0
    s_and_b32 s59, vcc_lo, s90
    s_cbranch_scc0 G2_pgB
    s_cmp_lt_u32 s58, 0x40000
    s_cbranch_scc0 G2_pgB
    s_sleep 1
    s_add_u32 s59, s91, 12288
    s_mov_b32 exec_lo, s90
    s_mov_b32 exec_hi, 0
    buffer_load_dword v5, v2, s[52:55], s59 offen sc1
    s_mov_b64 exec, -1
    s_waitcnt vmcnt(0)
    s_branch G2_pcB
G2_pgB:
G2_nb0:
    s_barrier
    ds_read_b64_tr_b16 v[124:125], v16 offset:34816
    ds_read_b64_tr_b16 v[126:127], v16 offset:36352
    ds_read_b64_tr_b16 v[128:129], v17 offset:34816
    ds_read_b64_tr_b16 v[130:131], v17 offset:36352
    ds_read_b64_tr_b16 v[132:133], v18 offset:34816
    ds_read_b64_tr_b16 v[134:135], v18 offset:36352
    ds_read_b128 v[24:27], v19 offset:34816
    ds_read_b128 v[32:35], v19 offset:36864
    ds_read_b128 v[40:43], v19 offset:38912
    ds_read_b128 v[48:51], v19 offset:40960
    ds_read_b128 v[56:59], v19 offset:43008
    s_waitcnt lgkmcnt(4)
    v_mfma_f32_16x16x32_bf16 v[64:67], v[124:127], v[24:27], v[64:67]
    ds_read_b64_tr_b16 v[136:137], v16 offset:47104
    ds_read_b64_tr_b16 v[138:139], v16 offset:48640
    v_mfma_f32_16x16x32_bf16 v[84:87], v[128:131], v[24:27], v[84:87]
    ds_read_b64_tr_b16 v[140:141], v17 offset:47104
    ds_read_b64_tr_b16 v[142:143], v17 offset:48640
    v_mfma_f32_16x16x32_bf16 v[104:107], v[132:135], v[24:27], v[104:107]
    ds_read_b64_tr_b16 v[144:145], v18 offset:47104
    ds_read_b64_tr_b16 v[146:147], v18 offset:48640
    s_waitcnt lgkmcnt(9)
    v_mfma_f32_16x16x32_bf16 v[68:71], v[124:127], v[32:35], v[68:71]
    ds_read_b128 v[28:31], v19 offset:35840
    v_mfma_f32_16x16x32_bf16 v[88:91], v[128:131], v[32:35], v[88:91]
    ds_read_b128 v[36:39], v19 offset:37888
    v_mfma_f32_16x16x32_bf16 v[108:111], v[132:135], v[32:35], v[108:111]
    ds_read_b128 v[44:47], v19 offset:39936
    s_waitcnt lgkmcnt(11)
    v_mfma_f32_16x16x32_bf16 v[72:75], v[124:127], v[40:43], v[72:75]
    ds_read_b128 v[52:55], v19 offset:41984
    v_mfma_f32_16x16x32_bf16 v[92:95], v[128:131], v[40:43], v[92:95]
    ds_read_b128 v[60:63], v19 offset:44032
    v_mfma_f32_16x16x32_bf16 v[112:115], v[132:135], v[40:43], v[112:115]
    s_waitcnt lgkmcnt(12)
    v_mfma_f32_16x16x32_bf16 v[76:79], v[124:127], v[48:51], v[76:79]
    v_mfma_f32_16x16x32_bf16 v[96:99], v[128:131], v[48:51], v[96:99]
    v_mfma_f32_16x16x32_bf16 v[116:119], v[132:135], v[48:51], v[116:119]
    s_waitcnt lgkmcnt(11)
    v_mfma_f32_16x16x32_bf16 v[80:83], v[124:127], v[56:59], v[80:83]
    v_mfma_f32_16x16x32_bf16 v[100:103], v[128:131], v[56:59], v[100:103]
    v_mfma_f32_16x16x32_bf16 v[120:123], v[132:135], v[56:59], v[120:123]
    s_waitcnt lgkmcnt(4)
    v_mfma_f32_16x16x32_bf16 v[64:67], v[136:139], v[28:31], v[64:67]
    v_mfma_f32_16x16x32_bf16 v[84:87], v[140:143], v[28:31], v[84:87]
    v_mfma_f32_16x16x32_bf16 v[104:107], v[144:147], v[28:31], v[104:107]
    s_waitcnt lgkmcnt(3)
    v_mfma_f32_16x16x32_bf16 v[68:71], v[136:139], v[36:39], v[68:71]
    v_mfma_f32_16x16x32_bf16 v[88:91], v[140:143], v[36:39], v[88:91]
    v_mfma_f32_16x16x32_bf16 v[108:111], v[144:147], v[36:39], v[108:111]
    s_waitcnt lgkmcnt(2)
    v_mfma_f32_16x16x32_bf16 v[72:75], v[136:139], v[44:47], v[72:75]
    v_mfma_f32_16x16x32_bf16 v[92:95], v[140:143], v[44:47], v[92:95]
    v_mfma_f32_16x16x32_bf16 v[112:115], v[144:147], v[44:47], v[112:115]
    s_waitcnt lgkmcnt(1)
    v_mfma_f32_16x16x32_bf16 v[76:79], v[136:139], v[52:55], v[76:79]
    v_mfma_f32_16x16x32_bf16 v[96:99], v[140:143], v[52:55], v[96:99]
    v_mfma_f32_16x16x32_bf16 v[116:119], v[144:147], v[52:55], v[116:119]
    s_waitcnt lgkmcnt(0)
    v_mfma_f32_16x16x32_bf16 v[80:83], v[136:139], v[60:63], v[80:83]
    v_mfma_f32_16x16x32_bf16 v[100:103], v[140:143], v[60:63], v[100:103]
    v_mfma_f32_16x16x32_bf16 v[120:123], v[144:147], v[60:63], v[120:123]
    s_lshl_b32 s59, s3, 3
    s_add_u32 s59, s59, s40
    s_cmp_lg_u32 s59, 12
    s_cbranch_scc1 G2_nl1
    s_mul_i32 s36, s15, 80
    s_lshr_b32 s91, s36, 8
    s_add_u32 s36, s36, 79
    s_lshr_b32 s36, s36, 8
    s_min_u32 s36, s36, 7
    s_cmp_eq_u32 s36, s91
    s_cselect_b32 s90, 1, 5
    s_lshl_b32 s91, s91, 7
    s_mov_b32 s89, 32
    s_add_u32 s59, s91, 32768
    s_mov_b32 exec_lo, s90
    s_mov_b32 exec_hi, 0
    buffer_load_dword v5, v2, s[52:55], s59 offen sc1
    s_mov_b64 exec, -1
G2_nl1:
    s_lshl_b32 s59, s3, 3
    s_add_u32 s59, s59, s40
    s_cmp_lg_u32 s59, 20
    s_cbranch_scc1 G2_nc1
    s_mov_b32 s91, 0
    s_mov_b32 s90, 1
    s_movk_i32 s89, 112
    s_add_u32 s59, s91, 43264
    s_mov_b32 exec_lo, s90
    s_mov_b32 exec_hi, 0
    buffer_load_dword v5, v2, s[52:55], s59 offen sc1
    s_mov_b64 exec, -1
G2_nc1:
    s_barrier
    ds_read_b64_tr_b16 v[124:125], v148 offset:0
    ds_read_b64_tr_b16 v[126:127], v148 offset:1536
    ds_read_b64_tr_b16 v[128:129], v149 offset:0
    ds_read_b64_tr_b16 v[130:131], v149 offset:1536
    ds_read_b64_tr_b16 v[132:133], v150 offset:0
    ds_read_b64_tr_b16 v[134:135], v150 offset:1536
    ds_read_b128 v[24:27], v151 offset:0
    ds_read_b128 v[32:35], v151 offset:2048
    ds_read_b128 v[40:43], v151 offset:4096
    ds_read_b128 v[48:51], v151 offset:6144
    ds_read_b128 v[56:59], v151 offset:8192
    s_waitcnt lgkmcnt(4)
    v_mfma_f32_16x16x32_bf16 v[64:67], v[124:127], v[24:27], v[64:67]
    ds_read_b64_tr_b16 v[136:137], v148 offset:12288
    ds_read_b64_tr_b16 v[138:139], v148 offset:13824
    v_mfma_f32_16x16x32_bf16 v[84:87], v[128:131], v[24:27], v[84:87]
    ds_read_b64_tr_b16 v[140:141], v149 offset:12288
    ds_read_b64_tr_b16 v[142:143], v149 offset:13824
    v_mfma_f32_16x16x32_bf16 v[104:107], v[132:135], v[24:27], v[104:107]
    ds_read_b64_tr_b16 v[144:145], v150 offset:12288
    ds_read_b64_tr_b16 v[146:147], v150 offset:13824
    s_waitcnt lgkmcnt(9)
    v_mfma_f32_16x16x32_bf16 v[68:71], v[124:127], v[32:35], v[68:71]
    ds_read_b128 v[28:31], v151 offset:1024
    v_mfma_f32_16x16x32_bf16 v[88:91], v[128:131], v[32:35], v[88:91]
    ds_read_b128 v[36:39], v151 offset:3072
    v_mfma_f32_16x16x32_bf16 v[108:111], v[132:135], v[32:35], v[108:111]
    ds_read_b128 v[44:47], v151 offset:5120
    s_waitcnt lgkmcnt(11)
    v_mfma_f32_16x16x32_bf16 v[72:75], v[124:127], v[40:43], v[72:75]
    ds_read_b128 v[52:55], v151 offset:7168
    v_mfma_f32_16x16x32_bf16 v[92:95], v[128:131], v[40:43], v[92:95]
    ds_read_b128 v[60:63], v151 offset:9216
    v_mfma_f32_16x16x32_bf16 v[112:115], v[132:135], v[40:43], v[112:115]
    s_waitcnt lgkmcnt(12)
    v_mfma_f32_16x16x32_bf16 v[76:79], v[124:127], v[48:51], v[76:79]
    v_mfma_f32_16x16x32_bf16 v[96:99], v[128:131], v[48:51], v[96:99]
    v_mfma_f32_16x16x32_bf16 v[116:119], v[132:135], v[48:51], v[116:119]
    s_waitcnt lgkmcnt(11)
    v_mfma_f32_16x16x32_bf16 v[80:83], v[124:127], v[56:59], v[80:83]
    v_mfma_f32_16x16x32_bf16 v[100:103], v[128:131], v[56:59], v[100:103]
    v_mfma_f32_16x16x32_bf16 v[120:123], v[132:135], v[56:59], v[120:123]
    s_waitcnt lgkmcnt(4)
    v_mfma_f32_16x16x32_bf16 v[64:67], v[136:139], v[28:31], v[64:67]
    v_mfma_f32_16x16x32_bf16 v[84:87], v[140:143], v[28:31], v[84:87]
    v_mfma_f32_16x16x32_bf16 v[104:107], v[144:147], v[28:31], v[104:107]
    s_waitcnt lgkmcnt(3)
    v_mfma_f32_16x16x32_bf16 v[68:71], v[136:139], v[36:39], v[68:71]
    v_mfma_f32_16x16x32_bf16 v[88:91], v[140:143], v[36:39], v[88:91]
    v_mfma_f32_16x16x32_bf16 v[108:111], v[144:147], v[36:39], v[108:111]
    s_waitcnt lgkmcnt(2)
    v_mfma_f32_16x16x32_bf16 v[72:75], v[136:139], v[44:47], v[72:75]
    v_mfma_f32_16x16x32_bf16 v[92:95], v[140:143], v[44:47], v[92:95]
    v_mfma_f32_16x16x32_bf16 v[112:115], v[144:147], v[44:47], v[112:115]
    s_waitcnt lgkmcnt(1)
    v_mfma_f32_16x16x32_bf16 v[76:79], v[136:139], v[52:55], v[76:79]
    v_mfma_f32_16x16x32_bf16 v[96:99], v[140:143], v[52:55], v[96:99]
    v_mfma_f32_16x16x32_bf16 v[116:119], v[144:147], v[52:55], v[116:119]
    s_waitcnt lgkmcnt(0)
    v_mfma_f32_16x16x32_bf16 v[80:83], v[136:139], v[60:63], v[80:83]
    v_mfma_f32_16x16x32_bf16 v[100:103], v[140:143], v[60:63], v[100:103]
    v_mfma_f32_16x16x32_bf16 v[120:123], v[144:147], v[60:63], v[120:123]
    s_lshl_b32 s59, s3, 3
    s_add_u32 s59, s59, s40
    s_cmp_lg_u32 s59, 1
    s_cbranch_scc1 G2_nb2
    s_add_u32 s59, s91, 12288
    s_mov_b32 exec_lo, s90
    s_mov_b32 exec_hi, 0
    buffer_load_dword v5, v2, s[52:55], s59 offen sc1
    s_mov_b64 exec, -1
G2_nb2:
    s_cmp_eq_u32 s40, 5
    s_cbranch_scc1 G2_last
    s_barrier
    ds_read_b64_tr_b16 v[124:125], v148 offset:34816
    ds_read_b64_tr_b16 v[126:127], v148 offset:36352
    ds_read_b64_tr_b16 v[128:129], v149 offset:34816
    ds_read_b64_tr_b16 v[130:131], v149 offset:36352
    ds_read_b64_tr_b16 v[132:133], v150 offset:34816
    ds_read_b64_tr_b16 v[134:135], v150 offset:36352
    ds_read_b128 v[24:27], v151 offset:34816
    ds_read_b128 v[32:35], v151 offset:36864
    ds_read_b128 v[40:43], v151 offset:38912
    ds_read_b128 v[48:51], v151 offset:40960
    ds_read_b128 v[56:59], v151 offset:43008
    s_waitcnt lgkmcnt(4)
    v_mfma_f32_16x16x32_bf16 v[64:67], v[124:127], v[24:27], v[64:67]
    ds_read_b64_tr_b16 v[136:137], v148 offset:47104
    ds_read_b64_tr_b16 v[138:139], v148 offset:48640
    v_mfma_f32_16x16x32_bf16 v[84:87], v[128:131], v[24:27], v[84:87]
    ds_read_b64_tr_b16 v[140:141], v149 offset:47104
    ds_read_b64_tr_b16 v[142:143], v149 offset:48640
    v_mfma_f32_16x16x32_bf16 v[104:107], v[132:135], v[24:27], v[104:107]
    ds_read_b64_tr_b16 v[144:145], v150 offset:47104
    ds_read_b64_tr_b16 v[146:147], v150 offset:48640
    s_waitcnt lgkmcnt(9)
    v_mfma_f32_16x16x32_bf16 v[68:71], v[124:127], v[32:35], v[68:71]
    ds_read_b128 v[28:31], v151 offset:35840
    v_mfma_f32_16x16x32_bf16 v[88:91], v[128:131], v[32:35], v[88:91]
    ds_read_b128 v[36:39], v151 offset:37888
    v_mfma_f32_16x16x32_bf16 v[108:111], v[132:135], v[32:35], v[108:111]
    ds_read_b128 v[44:47], v151 offset:39936
    s_waitcnt lgkmcnt(11)
    v_mfma_f32_16x16x32_bf16 v[72:75], v[124:127], v[40:43], v[72:75]
    ds_read_b128 v[52:55], v151 offset:41984
    v_mfma_f32_16x16x32_bf16 v[92:95], v[128:131], v[40:43], v[92:95]
    ds_read_b128 v[60:63], v151 offset:44032
    v_mfma_f32_16x16x32_bf16 v[112:115], v[132:135], v[40:43], v[112:115]
    s_waitcnt lgkmcnt(12)
    v_mfma_f32_16x16x32_bf16 v[76:79], v[124:127], v[48:51], v[76:79]
    v_mfma_f32_16x16x32_bf16 v[96:99], v[128:131], v[48:51], v[96:99]
    v_mfma_f32_16x16x32_bf16 v[116:119], v[132:135], v[48:51], v[116:119]
    s_waitcnt lgkmcnt(11)
    v_mfma_f32_16x16x32_bf16 v[80:83], v[124:127], v[56:59], v[80:83]
    v_mfma_f32_16x16x32_bf16 v[100:103], v[128:131], v[56:59], v[100:103]
    v_mfma_f32_16x16x32_bf16 v[120:123], v[132:135], v[56:59], v[120:123]
    s_waitcnt lgkmcnt(4)
    v_mfma_f32_16x16x32_bf16 v[64:67], v[136:139], v[28:31], v[64:67]
    v_mfma_f32_16x16x32_bf16 v[84:87], v[140:143], v[28:31], v[84:87]
    v_mfma_f32_16x16x32_bf16 v[104:107], v[144:147], v[28:31], v[104:107]
    s_waitcnt lgkmcnt(3)
    v_mfma_f32_16x16x32_bf16 v[68:71], v[136:139], v[36:39], v[68:71]
    v_mfma_f32_16x16x32_bf16 v[88:91], v[140:143], v[36:39], v[88:91]
    v_mfma_f32_16x16x32_bf16 v[108:111], v[144:147], v[36:39], v[108:111]
    s_waitcnt lgkmcnt(2)
    v_mfma_f32_16x16x32_bf16 v[72:75], v[136:139], v[44:47], v[72:75]
    v_mfma_f32_16x16x32_bf16 v[92:95], v[140:143], v[44:47], v[92:95]
    v_mfma_f32_16x16x32_bf16 v[112:115], v[144:147], v[44:47], v[112:115]
    s_waitcnt lgkmcnt(1)
    v_mfma_f32_16x16x32_bf16 v[76:79], v[136:139], v[52:55], v[76:79]
    v_mfma_f32_16x16x32_bf16 v[96:99], v[140:143], v[52:55], v[96:99]
    v_mfma_f32_16x16x32_bf16 v[116:119], v[144:147], v[52:55], v[116:119]
    s_waitcnt lgkmcnt(0)
    v_mfma_f32_16x16x32_bf16 v[80:83], v[136:139], v[60:63], v[80:83]
    v_mfma_f32_16x16x32_bf16 v[100:103], v[140:143], v[60:63], v[100:103]
    v_mfma_f32_16x16x32_bf16 v[120:123], v[144:147], v[60:63], v[120:123]
    s_lshl_b32 s59, s3, 3
    s_add_u32 s59, s59, s40
    s_cmp_lg_u32 s59, 12
    s_cbranch_scc1 G2_nl3
    s_waitcnt vmcnt(0)
    s_mov_b32 s58, 0
G2_pcL:
    v_cmp_gt_u32 vcc, s89, v5
    s_add_u32 s58, s58, 1
    s_nop 0
    s_and_b32 s59, vcc_lo, s90
    s_cbranch_scc0 G2_pgL
    s_cmp_lt_u32 s58, 0x40000
    s_cbranch_scc0 G2_pgL
    s_sleep 1
    s_add_u32 s59, s91, 32768
    s_mov_b32 exec_lo, s90
    s_mov_b32 exec_hi, 0
    buffer_load_dword v5, v2, s[52:55], s59 offen sc1
    s_mov_b64 exec, -1
    s_waitcnt vmcnt(0)
    s_branch G2_pcL
G2_pgL:
G2_nl3:
    s_lshl_b32 s59, s3, 3
    s_add_u32 s59, s59, s40
    s_cmp_lg_u32 s59, 20
    s_cbranch_scc1 G2_nc3
    s_waitcnt vmcnt(0)
    s_mov_b32 s58, 0
G2_pcC:
    v_cmp_gt_u32 vcc, s89, v5
    s_add_u32 s58, s58, 1
    s_nop 0
    s_and_b32 s59, vcc_lo, s90
    s_cbranch_scc0 G2_pgC
    s_cmp_lt_u32 s58, 0x40000
    s_cbranch_scc0 G2_pgC
    s_sleep 1
    s_add_u32 s59, s91, 43264
    s_mov_b32 exec_lo, s90
    s_mov_b32 exec_hi, 0
    buffer_load_dword v5, v2, s[52:55], s59 offen sc1
    s_mov_b64 exec, -1
    s_waitcnt vmcnt(0)
    s_branch G2_pcC
G2_pgC:
G2_nc3:
    s_add_u32 s40, s40, 1
    s_branch G2_cloop
G2_last:
    s_mov_b32 s37, 0
    buffer_load_dwordx2 v[180:181], v11, s[48:51], s37 offen sc1
    s_mov_b32 s37, 18432
    buffer_load_dwordx2 v[182:183], v11, s[48:51], s37 offen sc1
    s_mov_b32 s37, 36864
    buffer_load_dwordx2 v[184:185], v11, s[48:51], s37 offen sc1
    s_mov_b32 s37, 55296
    buffer_load_dwordx2 v[186:187], v11, s[48:51], s37 offen sc1
    s_mov_b32 s37, 73728
    buffer_load_dwordx2 v[188:189], v11, s[48:51], s37 offen sc1
    s_barrier
    ds_read_b64_tr_b16 v[124:125], v148 offset:34816
    ds_read_b64_tr_b16 v[126:127], v148 offset:36352
    ds_read_b64_tr_b16 v[128:129], v149 offset:34816
    ds_read_b64_tr_b16 v[130:131], v149 offset:36352
    ds_read_b64_tr_b16 v[132:133], v150 offset:34816
    ds_read_b64_tr_b16 v[134:135], v150 offset:36352
    ds_read_b128 v[24:27], v151 offset:34816
    ds_read_b128 v[32:35], v151 offset:36864
    ds_read_b128 v[40:43], v151 offset:38912
    ds_read_b128 v[48:51], v151 offset:40960
    ds_read_b128 v[56:59], v151 offset:43008
    s_waitcnt lgkmcnt(4)
    v_mfma_f32_16x16x32_bf16 v[64:67], v[124:127], v[24:27], v[64:67]
    ds_read_b64_tr_b16 v[136:137], v148 offset:47104
    ds_read_b64_tr_b16 v[138:139], v148 offset:48640
    v_mfma_f32_16x16x32_bf16 v[84:87], v[128:131], v[24:27], v[84:87]
    ds_read_b64_tr_b16 v[140:141], v149 offset:47104
    ds_read_b64_tr_b16 v[142:143], v149 offset:48640
    s_waitcnt lgkmcnt(7)
    v_mfma_f32_16x16x32_bf16 v[68:71], v[124:127], v[32:35], v[68:71]
    ds_read_b64_tr_b16 v[144:145], v150 offset:47104
    ds_read_b64_tr_b16 v[146:147], v150 offset:48640
    v_mfma_f32_16x16x32_bf16 v[88:91], v[128:131], v[32:35], v[88:91]
    ds_read_b128 v[28:31], v151 offset:35840
    s_waitcnt lgkmcnt(9)
    v_mfma_f32_16x16x32_bf16 v[72:75], v[124:127], v[40:43], v[72:75]
    ds_read_b128 v[36:39], v151 offset:37888
    v_mfma_f32_16x16x32_bf16 v[92:95], v[128:131], v[40:43], v[92:95]
    ds_read_b128 v[44:47], v151 offset:39936
    s_waitcnt lgkmcnt(10)
    v_mfma_f32_16x16x32_bf16 v[76:79], v[124:127], v[48:51], v[76:79]
    ds_read_b128 v[52:55], v151 offset:41984
    v_mfma_f32_16x16x32_bf16 v[96:99], v[128:131], v[48:51], v[96:99]
    ds_read_b128 v[60:63], v151 offset:44032
    s_waitcnt lgkmcnt(11)
    v_mfma_f32_16x16x32_bf16 v[80:83], v[124:127], v[56:59], v[80:83]
    v_mfma_f32_16x16x32_bf16 v[100:103], v[128:131], v[56:59], v[100:103]
    s_waitcnt lgkmcnt(4)
    v_mfma_f32_16x16x32_bf16 v[64:67], v[136:139], v[28:31], v[64:67]
    s_waitcnt lgkmcnt(3)
    v_mfma_f32_16x16x32_bf16 v[68:71], v[136:139], v[36:39], v[68:71]
    s_waitcnt lgkmcnt(2)
    v_mfma_f32_16x16x32_bf16 v[72:75], v[136:139], v[44:47], v[72:75]
    s_waitcnt lgkmcnt(1)
    v_mfma_f32_16x16x32_bf16 v[76:79], v[136:139], v[52:55], v[76:79]
    s_waitcnt lgkmcnt(0)
    v_mfma_f32_16x16x32_bf16 v[80:83], v[136:139], v[60:63], v[80:83]
    v_mfma_f32_16x16x32_bf16 v[84:87], v[140:143], v[28:31], v[84:87]
    v_mfma_f32_16x16x32_bf16 v[88:91], v[140:143], v[36:39], v[88:91]
    v_cvt_pk_bf16_f32 v152, v64, v65
    v_cvt_pk_bf16_f32 v153, v66, v67
    v_cvt_pk_bf16_f32 v154, v68, v69
    v_mfma_f32_16x16x32_bf16 v[92:95], v[140:143], v[44:47], v[92:95]
    v_cvt_pk_bf16_f32 v155, v70, v71
    buffer_store_dwordx4 v[152:155], v10, s[24:27], s32 offen sc0 sc1
    v_cvt_pk_bf16_f32 v156, v72, v73
    v_mfma_f32_16x16x32_bf16 v[96:99], v[140:143], v[52:55], v[96:99]
    v_cvt_pk_bf16_f32 v157, v74, v75
    v_cvt_pk_bf16_f32 v158, v76, v77
    v_cvt_pk_bf16_f32 v159, v78, v79
    v_mfma_f32_16x16x32_bf16 v[100:103], v[140:143], v[60:63], v[100:103]
    buffer_store_dwordx4 v[156:159], v10, s[24:27], s32 offen offset:1024 sc0 sc1
    v_cvt_pk_bf16_f32 v160, v80, v81
    v_cvt_pk_bf16_f32 v161, v82, v83
    v_mfma_f32_16x16x32_bf16 v[104:107], v[132:135], v[24:27], v[104:107]
    buffer_store_dwordx2 v[160:161], v9, s[24:27], s32 offen offset:2048 sc0 sc1
    v_mfma_f32_16x16x32_bf16 v[108:111], v[132:135], v[32:35], v[108:111]
    v_cvt_pk_bf16_f32 v164, v84, v85
    v_cvt_pk_bf16_f32 v165, v86, v87
    v_cvt_pk_bf16_f32 v166, v88, v89
    v_mfma_f32_16x16x32_bf16 v[112:115], v[132:135], v[40:43], v[112:115]
    v_cvt_pk_bf16_f32 v167, v90, v91
    buffer_store_dwordx4 v[164:167], v10, s[24:27], s33 offen sc0 sc1
    v_cvt_pk_bf16_f32 v168, v92, v93
    v_mfma_f32_16x16x32_bf16 v[116:119], v[132:135], v[48:51], v[116:119]
    v_cvt_pk_bf16_f32 v169, v94, v95
    v_cvt_pk_bf16_f32 v170, v96, v97
    v_cvt_pk_bf16_f32 v171, v98, v99
    v_mfma_f32_16x16x32_bf16 v[120:123], v[132:135], v[56:59], v[120:123]
    buffer_store_dwordx4 v[168:171], v10, s[24:27], s33 offen offset:1024 sc0 sc1
    v_cvt_pk_bf16_f32 v172, v100, v101
    v_cvt_pk_bf16_f32 v173, v102, v103
    v_mfma_f32_16x16x32_bf16 v[104:107], v[144:147], v[28:31], v[104:107]
    buffer_store_dwordx2 v[172:173], v9, s[24:27], s33 offen offset:2048 sc0 sc1
    v_mfma_f32_16x16x32_bf16 v[108:111], v[144:147], v[36:39], v[108:111]
    v_mfma_f32_16x16x32_bf16 v[112:115], v[144:147], v[44:47], v[112:115]
    v_mfma_f32_16x16x32_bf16 v[116:119], v[144:147], v[52:55], v[116:119]
    v_mfma_f32_16x16x32_bf16 v[120:123], v[144:147], v[60:63], v[120:123]
    s_mov_b32 s37, s35
    s_mov_b32 s38, s34
    s_mov_b32 s58, 0
G2_xpoll:
    buffer_load_dwordx4 v[64:67], v10, s[24:27], s37 offen sc0 sc1
    buffer_load_dwordx4 v[76:79], v10, s[24:27], s38 offen sc0 sc1
    buffer_load_dwordx4 v[68:71], v10, s[24:27], s37 offen offset:1024 sc0 sc1
    buffer_load_dwordx4 v[80:83], v10, s[24:27], s38 offen offset:1024 sc0 sc1
    buffer_load_dwordx2 v[72:73], v9, s[24:27], s37 offen offset:2048 sc0 sc1
    buffer_load_dwordx2 v[84:85], v9, s[24:27], s38 offen offset:2048 sc0 sc1
    s_add_u32 s58, s58, 1
    s_waitcnt vmcnt(0)
    v_max3_u32 v12, v64, v65, v66
    v_max3_u32 v13, v67, v68, v69
    v_max3_u32 v14, v70, v71, v72
    v_max3_u32 v15, v73, v76, v77
    v_max3_u32 v12, v12, v78, v79
    v_max3_u32 v13, v13, v80, v81
    v_max3_u32 v14, v14, v82, v83
    v_max3_u32 v15, v15, v84, v85
    v_max3_u32 v12, v12, v13, v14
    v_max_u32 v12, v12, v15
    v_cmp_eq_u32 vcc, -1, v12
    s_cmp_lt_u32 s58, 0x10000
    s_cbranch_scc0 G2_xgo
    s_cbranch_vccnz G2_xpoll
G2_xgo:
    s_mov_b32 s38, 0xffff0000
    v_lshlrev_b32 v88, 16, v64
    v_and_b32 v89, s38, v64
    v_lshlrev_b32 v90, 16, v65
    v_and_b32 v91, s38, v65
    v_pk_add_f32 v[104:105], v[104:105], v[88:89]
    v_pk_add_f32 v[106:107], v[106:107], v[90:91]
    v_lshlrev_b32 v88, 16, v76
    v_and_b32 v89, s38, v76
    v_lshlrev_b32 v90, 16, v77
    v_and_b32 v91, s38, v77
    v_pk_add_f32 v[104:105], v[104:105], v[88:89]
    v_pk_add_f32 v[106:107], v[106:107], v[90:91]
    v_cvt_pk_bf16_f32 v14, v104, v105
    v_cvt_pk_bf16_f32 v15, v106, v107
    v_lshlrev_b32 v104, 16, v14
    v_and_b32 v105, s38, v14
    v_lshlrev_b32 v106, 16, v15
    v_and_b32 v107, s38, v15
    v_lshlrev_b32 v88, 16, v180
    v_and_b32 v89, s38, v180
    v_lshlrev_b32 v90, 16, v181
    v_and_b32 v91, s38, v181
    v_pk_add_f32 v[104:105], v[104:105], v[88:89]
    v_pk_add_f32 v[106:107], v[106:107], v[90:91]
    v_cvt_pk_bf16_f32 v180, v104, v105
    v_cvt_pk_bf16_f32 v181, v106, v107
    s_mov_b32 s37, 0
    buffer_store_dwordx2 v[180:181], v11, s[4:7], s37 offen sc1
    v_lshlrev_b32 v88, 16, v66
    v_and_b32 v89, s38, v66
    v_lshlrev_b32 v90, 16, v67
    v_and_b32 v91, s38, v67
    v_pk_add_f32 v[108:109], v[108:109], v[88:89]
    v_pk_add_f32 v[110:111], v[110:111], v[90:91]
    v_lshlrev_b32 v88, 16, v78
    v_and_b32 v89, s38, v78
    v_lshlrev_b32 v90, 16, v79
    v_and_b32 v91, s38, v79
    v_pk_add_f32 v[108:109], v[108:109], v[88:89]
    v_pk_add_f32 v[110:111], v[110:111], v[90:91]
    v_cvt_pk_bf16_f32 v14, v108, v109
    v_cvt_pk_bf16_f32 v15, v110, v111
    v_lshlrev_b32 v108, 16, v14
    v_and_b32 v109, s38, v14
    v_lshlrev_b32 v110, 16, v15
    v_and_b32 v111, s38, v15
    v_lshlrev_b32 v88, 16, v182
    v_and_b32 v89, s38, v182
    v_lshlrev_b32 v90, 16, v183
    v_and_b32 v91, s38, v183
    v_pk_add_f32 v[108:109], v[108:109], v[88:89]
    v_pk_add_f32 v[110:111], v[110:111], v[90:91]
    v_cvt_pk_bf16_f32 v182, v108, v109
    v_cvt_pk_bf16_f32 v183, v110, v111
    s_mov_b32 s37, 18432
    buffer_store_dwordx2 v[182:183], v11, s[4:7], s37 offen sc1
    v_lshlrev_b32 v88, 16, v68
    v_and_b32 v89, s38, v68
    v_lshlrev_b32 v90, 16, v69
    v_and_b32 v91, s38, v69
    v_pk_add_f32 v[112:113], v[112:113], v[88:89]
    v_pk_add_f32 v[114:115], v[114:115], v[90:91]
    v_lshlrev_b32 v88, 16, v80
    v_and_b32 v89, s38, v80
    v_lshlrev_b32 v90, 16, v81
    v_and_b32 v91, s38, v81
    v_pk_add_f32 v[112:113], v[112:113], v[88:89]
    v_pk_add_f32 v[114:115], v[114:115], v[90:91]
    v_cvt_pk_bf16_f32 v14, v112, v113
    v_cvt_pk_bf16_f32 v15, v114, v115
    v_lshlrev_b32 v112, 16, v14
    v_and_b32 v113, s38, v14
    v_lshlrev_b32 v114, 16, v15
    v_and_b32 v115, s38, v15
    v_lshlrev_b32 v88, 16, v184
    v_and_b32 v89, s38, v184
    v_lshlrev_b32 v90, 16, v185
    v_and_b32 v91, s38, v185
    v_pk_add_f32 v[112:113], v[112:113], v[88:89]
    v_pk_add_f32 v[114:115], v[114:115], v[90:91]
    v_cvt_pk_bf16_f32 v184, v112, v113
    v_cvt_pk_bf16_f32 v185, v114, v115
    s_mov_b32 s37, 36864
    buffer_store_dwordx2 v[184:185], v11, s[4:7], s37 offen sc1
    v_lshlrev_b32 v88, 16, v70
    v_and_b32 v89, s38, v70
    v_lshlrev_b32 v90, 16, v71
    v_and_b32 v91, s38, v71
    v_pk_add_f32 v[116:117], v[116:117], v[88:89]
    v_pk_add_f32 v[118:119], v[118:119], v[90:91]
    v_lshlrev_b32 v88, 16, v82
    v_and_b32 v89, s38, v82
    v_lshlrev_b32 v90, 16, v83
    v_and_b32 v91, s38, v83
    v_pk_add_f32 v[116:117], v[116:117], v[88:89]
    v_pk_add_f32 v[118:119], v[118:119], v[90:91]
    v_cvt_pk_bf16_f32 v14, v116, v117
    v_cvt_pk_bf16_f32 v15, v118, v119
    v_lshlrev_b32 v116, 16, v14
    v_and_b32 v117, s38, v14
    v_lshlrev_b32 v118, 16, v15
    v_and_b32 v119, s38, v15
    v_lshlrev_b32 v88, 16, v186
    v_and_b32 v89, s38, v186
    v_lshlrev_b32 v90, 16, v187
    v_and_b32 v91, s38, v187
    v_pk_add_f32 v[116:117], v[116:117], v[88:89]
    v_pk_add_f32 v[118:119], v[118:119], v[90:91]
    v_cvt_pk_bf16_f32 v186, v116, v117
    v_cvt_pk_bf16_f32 v187, v118, v119
    s_mov_b32 s37, 55296
    buffer_store_dwordx2 v[186:187], v11, s[4:7], s37 offen sc1
    v_lshlrev_b32 v88, 16, v72
    v_and_b32 v89, s38, v72
    v_lshlrev_b32 v90, 16, v73
    v_and_b32 v91, s38, v73
    v_pk_add_f32 v[120:121], v[120:121], v[88:89]
    v_pk_add_f32 v[122:123], v[122:123], v[90:91]
    v_lshlrev_b32 v88, 16, v84
    v_and_b32 v89, s38, v84
    v_lshlrev_b32 v90, 16, v85
    v_and_b32 v91, s38, v85
    v_pk_add_f32 v[120:121], v[120:121], v[88:89]
    v_pk_add_f32 v[122:123], v[122:123], v[90:91]
    v_cvt_pk_bf16_f32 v14, v120, v121
    v_cvt_pk_bf16_f32 v15, v122, v123
    v_lshlrev_b32 v120, 16, v14
    v_and_b32 v121, s38, v14
    v_lshlrev_b32 v122, 16, v15
    v_and_b32 v123, s38, v15
    v_lshlrev_b32 v88, 16, v188
    v_and_b32 v89, s38, v188
    v_lshlrev_b32 v90, 16, v189
    v_and_b32 v91, s38, v189
    v_pk_add_f32 v[120:121], v[120:121], v[88:89]
    v_pk_add_f32 v[122:123], v[122:123], v[90:91]
    v_cvt_pk_bf16_f32 v188, v120, v121
    v_cvt_pk_bf16_f32 v189, v122, v123
    s_mov_b32 s37, 73728
    buffer_store_dwordx2 v[188:189], v11, s[4:7], s37 offen sc1
    s_branch G2_end
G2_loader:
    s_cmp_lg_u32 s3, 4
    s_cbranch_scc1 G2_la
    s_waitcnt vmcnt(1)
    s_mov_b32 s58, 0
G2_pcA:
    v_cmp_gt_u32 vcc, s89, v5
    s_add_u32 s58, s58, 1
    s_nop 0
    s_and_b32 s59, vcc_lo, s90
    s_cbranch_scc0 G2_pgA
    s_cmp_lt_u32 s58, 0x40000
    s_cbranch_scc0 G2_pgA
    s_sleep 1
    s_add_u32 s59, s91, 0
    s_mov_b32 exec_lo, s90
    s_mov_b32 exec_hi, 0
    buffer_load_dword v5, v2, s[52:55], s59 offen sc1
    s_mov_b64 exec, -1
    s_waitcnt vmcnt(0)
    s_branch G2_pcA
G2_pgA:
G2_la:
    s_mul_i32 s19, s13, 384
    s_movk_i32 s38, 1152
    v_add_u32 v10, s19, v0
    v_mul_u32_u24 v11, 2731, v10
    v_lshrrev_b32 v11, 16, v11
    v_mul_u32_u24 v15, 24, v11
    v_sub_u32 v15, v10, v15
    v_bfe_u32 v16, v11, 1, 1
    v_bfe_u32 v14, v11, 3, 1
    v_lshl_or_b32 v16, v14, 1, v16
    v_lshlrev_b32 v16, 1, v16
    v_xor_b32 v15, v15, v16
    v_mul_u32_u24 v11, s38, v11
    v_lshl_add_u32 v24, v15, 4, v11
    v_add_u32 v10, s19, v0
    v_add_u32 v10, 64, v10
    v_mul_u32_u24 v11, 2731, v10
    v_lshrrev_b32 v11, 16, v11
    v_mul_u32_u24 v15, 24, v11
    v_sub_u32 v15, v10, v15
    v_bfe_u32 v16, v11, 1, 1
    v_bfe_u32 v14, v11, 3, 1
    v_lshl_or_b32 v16, v14, 1, v16
    v_lshlrev_b32 v16, 1, v16
    v_xor_b32 v15, v15, v16
    v_mul_u32_u24 v11, s38, v11
    v_lshl_add_u32 v25, v15, 4, v11
    v_subrev_u32 v25, 1024, v25
    v_add_u32 v10, s19, v0
    v_add_u32 v10, 128, v10
    v_mul_u32_u24 v11, 2731, v10
    v_lshrrev_b32 v11, 16, v11
    v_mul_u32_u24 v15, 24, v11
    v_sub_u32 v15, v10, v15
    v_bfe_u32 v16, v11, 1, 1
    v_bfe_u32 v14, v11, 3, 1
    v_lshl_or_b32 v16, v14, 1, v16
    v_lshlrev_b32 v16, 1, v16
    v_xor_b32 v15, v15, v16
    v_mul_u32_u24 v11, s38, v11
    v_lshl_add_u32 v26, v15, 4, v11
    v_subrev_u32 v26, 2048, v26
    v_add_u32 v10, s19, v0
    v_add_u32 v10, 192, v10
    v_mul_u32_u24 v11, 2731, v10
    v_lshrrev_b32 v11, 16, v11
    v_mul_u32_u24 v15, 24, v11
    v_sub_u32 v15, v10, v15
    v_bfe_u32 v16, v11, 1, 1
    v_bfe_u32 v14, v11, 3, 1
    v_lshl_or_b32 v16, v14, 1, v16
    v_lshlrev_b32 v16, 1, v16
    v_xor_b32 v15, v15, v16
    v_mul_u32_u24 v11, s38, v11
    v_lshl_add_u32 v27, v15, 4, v11
    v_add_u32 v10, s19, v0
    v_add_u32 v10, 256, v10
    v_mul_u32_u24 v11, 2731, v10
    v_lshrrev_b32 v11, 16, v11
    v_mul_u32_u24 v15, 24, v11
    v_sub_u32 v15, v10, v15
    v_bfe_u32 v16, v11, 1, 1
    v_bfe_u32 v14, v11, 3, 1
    v_lshl_or_b32 v16, v14, 1, v16
    v_lshlrev_b32 v16, 1, v16
    v_xor_b32 v15, v15, v16
    v_mul_u32_u24 v11, s38, v11
    v_lshl_add_u32 v28, v15, 4, v11
    v_subrev_u32 v28, 1024, v28
    v_add_u32 v10, s19, v0
    v_add_u32 v10, 320, v10
    v_mul_u32_u24 v11, 2731, v10
    v_lshrrev_b32 v11, 16, v11
    v_mul_u32_u24 v15, 24, v11
    v_sub_u32 v15, v10, v15
    v_bfe_u32 v16, v11, 1, 1
    v_bfe_u32 v14, v11, 3, 1
    v_lshl_or_b32 v16, v14, 1, v16
    v_lshlrev_b32 v16, 1, v16
    v_xor_b32 v15, v15, v16
    v_mul_u32_u24 v11, s38, v11
    v_lshl_add_u32 v29, v15, 4, v11
    v_subrev_u32 v29, 2048, v29
    s_mul_i32 s19, s13, 3
    s_cmp_eq_u32 s13, 3
    s_cselect_b32 s19, 8, s19
    v_lshlrev_b32 v10, 4, v0
    s_add_u32 s36, s19, 0
    s_lshr_b32 s38, s36, 1
    s_mul_i32 s38, s38, 147456
    s_and_b32 s36, s36, 1
    s_lshl_b32 s36, s36, 10
    s_add_u32 s38, s38, s36
    v_add_u32 v30, s38, v10
    s_add_u32 s36, s19, 1
    s_lshr_b32 s38, s36, 1
    s_mul_i32 s38, s38, 147456
    s_and_b32 s36, s36, 1
    s_lshl_b32 s36, s36, 10
    s_add_u32 s38, s38, s36
    s_sub_u32 s38, s38, 1024
    v_add_u32 v31, s38, v10
    s_add_u32 s36, s19, 2
    s_lshr_b32 s38, s36, 1
    s_mul_i32 s38, s38, 147456
    s_and_b32 s36, s36, 1
    s_lshl_b32 s36, s36, 10
    s_add_u32 s38, s38, s36
    s_cmp_ge_u32 s13, 2
    s_cselect_b32 s38, 0x7f000000, s38
    v_add_u32 v32, s38, v10
    s_cmp_ge_u32 s13, 2
    s_cselect_b32 s82, 1, 0
    s_mul_i32 s88, s17, 1769472
    s_mul_i32 s38, s16, 384
    s_add_u32 s88, s88, s38
    s_mul_i32 s87, s15, 737280
    s_mul_i32 s38, s17, 49152
    s_add_u32 s87, s87, s38
    s_mul_i32 s34, s13, 6144
    s_lshl_b32 s35, s19, 10
    s_add_u32 s35, s35, 24576
    s_mul_i32 s83, s17, 6
    s_cmp_eq_u32 s17, 2
    s_cselect_b32 s83, 3, s83
    s_mov_b32 s86, -1
    s_sub_u32 s85, s83, 1
    s_movk_i32 s84, 0x156
    s_call_b64 s[36:37], G2_next
    s_add_u32 m0, s34, 0
    s_nop 0
    buffer_load_dwordx4 v24, s[20:23], s32 offen lds
    buffer_load_dwordx4 v25, s[20:23], s32 offen offset:1024 lds
    buffer_load_dwordx4 v26, s[20:23], s32 offen offset:2048 lds
    s_add_u32 m0, m0, 3072
    s_nop 0
    buffer_load_dwordx4 v27, s[20:23], s32 offen lds
    buffer_load_dwordx4 v28, s[20:23], s32 offen offset:1024 lds
    buffer_load_dwordx4 v29, s[20:23], s32 offen offset:2048 lds
    s_barrier
    s_add_u32 m0, s35, 0
    s_nop 0
    buffer_load_dwordx4 v30, s[28:31], s33 offen sc1 lds
    buffer_load_dwordx4 v31, s[28:31], s33 offen offset:1024 sc1 lds
    s_add_u32 s38, m0, 2048
    s_cmp_eq_u32 s82, 1
    s_cselect_b32 m0, 139264, s38
    s_nop 0
    buffer_load_dwordx4 v32, s[28:31], s33 offen sc1 lds
    s_call_b64 s[36:37], G2_next
    s_add_u32 m0, s34, 34816
    s_nop 0
    buffer_load_dwordx4 v24, s[20:23], s32 offen lds
    buffer_load_dwordx4 v25, s[20:23], s32 offen offset:1024 lds
    buffer_load_dwordx4 v26, s[20:23], s32 offen offset:2048 lds
    s_add_u32 m0, m0, 3072
    s_nop 0
    buffer_load_dwordx4 v27, s[20:23], s32 offen lds
    buffer_load_dwordx4 v28, s[20:23], s32 offen offset:1024 lds
    buffer_load_dwordx4 v29, s[20:23], s32 offen offset:2048 lds
    s_add_u32 m0, s35, 34816
    s_nop 0
    buffer_load_dwordx4 v30, s[28:31], s33 offen sc1 lds
    buffer_load_dwordx4 v31, s[28:31], s33 offen offset:1024 sc1 lds
    s_add_u32 s38, m0, 2048
    s_cmp_eq_u32 s82, 1
    s_cselect_b32 m0, 139264, s38
    s_nop 0
    buffer_load_dwordx4 v32, s[28:31], s33 offen sc1 lds
    s_call_b64 s[36:37], G2_next
    s_add_u32 m0, s34, 69632
    s_nop 0
    buffer_load_dwordx4 v24, s[20:23], s32 offen lds
    buffer_load_dwordx4 v25, s[20:23], s32 offen offset:1024 lds
    buffer_load_dwordx4 v26, s[20:23], s32 offen offset:2048 lds
    s_add_u32 m0, m0, 3072
    s_nop 0
    buffer_load_dwordx4 v27, s[20:23], s32 offen lds
    buffer_load_dwordx4 v28, s[20:23], s32 offen offset:1024 lds
    buffer_load_dwordx4 v29, s[20:23], s32 offen offset:2048 lds
    s_add_u32 m0, s35, 69632
    s_nop 0
    buffer_load_dwordx4 v30, s[28:31], s33 offen sc1 lds
    buffer_load_dwordx4 v31, s[28:31], s33 offen offset:1024 sc1 lds
    s_add_u32 s38, m0, 2048
    s_cmp_eq_u32 s82, 1
    s_cselect_b32 m0, 139264, s38
    s_nop 0
    buffer_load_dwordx4 v32, s[28:31], s33 offen sc1 lds
    s_mov_b32 s40, 0
G2_lloop:
    s_waitcnt vmcnt(18)
    s_barrier
    s_call_b64 s[36:37], G2_next
    s_add_u32 m0, s34, 104448
    s_nop 0
    buffer_load_dwordx4 v24, s[20:23], s32 offen lds
    buffer_load_dwordx4 v25, s[20:23], s32 offen offset:1024 lds
    buffer_load_dwordx4 v26, s[20:23], s32 offen offset:2048 lds
    s_add_u32 m0, m0, 3072
    s_nop 0
    buffer_load_dwordx4 v27, s[20:23], s32 offen lds
    buffer_load_dwordx4 v28, s[20:23], s32 offen offset:1024 lds
    buffer_load_dwordx4 v29, s[20:23], s32 offen offset:2048 lds
    s_add_u32 m0, s35, 104448
    s_nop 0
    buffer_load_dwordx4 v30, s[28:31], s33 offen sc1 lds
    buffer_load_dwordx4 v31, s[28:31], s33 offen offset:1024 sc1 lds
    s_add_u32 s38, m0, 2048
    s_cmp_eq_u32 s82, 1
    s_cselect_b32 m0, 139264, s38
    s_nop 0
    buffer_load_dwordx4 v32, s[28:31], s33 offen sc1 lds
    s_waitcnt vmcnt(18)
    s_barrier
    s_call_b64 s[36:37], G2_next
    s_add_u32 m0, s34, 0
    s_nop 0
    buffer_load_dwordx4 v24, s[20:23], s32 offen lds
    buffer_load_dwordx4 v25, s[20:23], s32 offen offset:1024 lds
    buffer_load_dwordx4 v26, s[20:23], s32 offen offset:2048 lds
    s_add_u32 m0, m0, 3072
    s_nop 0
    buffer_load_dwordx4 v27, s[20:23], s32 offen lds
    buffer_load_dwordx4 v28, s[20:23], s32 offen offset:1024 lds
    buffer_load_dwordx4 v29, s[20:23], s32 offen offset:2048 lds
    s_add_u32 m0, s35, 0
    s_nop 0
    buffer_load_dwordx4 v30, s[28:31], s33 offen sc1 lds
    buffer_load_dwordx4 v31, s[28:31], s33 offen offset:1024 sc1 lds
    s_add_u32 s38, m0, 2048
    s_cmp_eq_u32 s82, 1
    s_cselect_b32 m0, 139264, s38
    s_nop 0
    buffer_load_dwordx4 v32, s[28:31], s33 offen sc1 lds
    s_waitcnt vmcnt(18)
    s_barrier
    s_call_b64 s[36:37], G2_next
    s_add_u32 m0, s34, 34816
    s_nop 0
    buffer_load_dwordx4 v24, s[20:23], s32 offen lds
    buffer_load_dwordx4 v25, s[20:23], s32 offen offset:1024 lds
    buffer_load_dwordx4 v26, s[20:23], s32 offen offset:2048 lds
    s_add_u32 m0, m0, 3072
    s_nop 0
    buffer_load_dwordx4 v27, s[20:23], s32 offen lds
    buffer_load_dwordx4 v28, s[20:23], s32 offen offset:1024 lds
    buffer_load_dwordx4 v29, s[20:23], s32 offen offset:2048 lds
    s_add_u32 m0, s35, 34816
    s_nop 0
    buffer_load_dwordx4 v30, s[28:31], s33 offen sc1 lds
    buffer_load_dwordx4 v31, s[28:31], s33 offen offset:1024 sc1 lds
    s_add_u32 s38, m0, 2048
    s_cmp_eq_u32 s82, 1
    s_cselect_b32 m0, 139264, s38
    s_nop 0
    buffer_load_dwordx4 v32, s[28:31], s33 offen sc1 lds
    s_waitcnt vmcnt(18)
    s_barrier
    s_call_b64 s[36:37], G2_next
    s_add_u32 m0, s34, 69632
    s_nop 0
    buffer_load_dwordx4 v24, s[20:23], s32 offen lds
    buffer_load_dwordx4 v25, s[20:23], s32 offen offset:1024 lds
    buffer_load_dwordx4 v26, s[20:23], s32 offen offset:2048 lds
    s_add_u32 m0, m0, 3072
    s_nop 0
    buffer_load_dwordx4 v27, s[20:23], s32 offen lds
    buffer_load_dwordx4 v28, s[20:23], s32 offen offset:1024 lds
    buffer_load_dwordx4 v29, s[20:23], s32 offen offset:2048 lds
    s_add_u32 m0, s35, 69632
    s_nop 0
    buffer_load_dwordx4 v30, s[28:31], s33 offen sc1 lds
    buffer_load_dwordx4 v31, s[28:31], s33 offen offset:1024 sc1 lds
    s_add_u32 s38, m0, 2048
    s_cmp_eq_u32 s82, 1
    s_cselect_b32 m0, 139264, s38
    s_nop 0
    buffer_load_dwordx4 v32, s[28:31], s33 offen sc1 lds
    s_add_u32 s40, s40, 1
    s_cmp_lt_u32 s40, 6
    s_cbranch_scc1 G2_lloop
    s_branch G2_end
G2_next:
    s_add_u32 s86, s86, 1
    s_add_u32 s85, s85, 1
    s_cmp_eq_u32 s85, 9
    s_cselect_b32 s85, 0, s85
    s_cmp_lg_u32 s86, 24
    s_cbranch_scc1 G2_n1
    s_cmp_eq_u32 s84, 0xa9
    s_cbranch_scc1 G2_n2
    s_mov_b32 s86, 0
    s_mov_b32 s85, s83
    s_movk_i32 s84, 0xa9
G2_n1:
    s_bitcmp1_b32 s84, s85
    s_cbranch_scc0 G2_next
    s_mul_i32 s32, s86, 73728
    s_add_u32 s32, s32, s88
    s_lshl_b32 s33, s86, 11
    s_add_u32 s33, s33, s87
    s_setpc_b64 s[36:37]
G2_n2:
    s_mov_b32 s86, 23
    s_mov_b32 s32, 0x7f000000
    s_mov_b32 s33, 0x7f000000
    s_setpc_b64 s[36:37]
G2_end:
    s_endpgm
KB_tr0:
    s_add_u32 s58, s58, 1
    s_cmp_lt_u32 s58, 0x20000
    s_cbranch_scc0 KB_tb0
    s_add_u32 s59, s42, 0
    s_sleep 2
    buffer_load_dwordx4 v[48:51], v8, s[24:27], s59 offen offset:0 sc0 sc1
    buffer_load_dwordx4 v[52:55], v8, s[24:27], s59 offen offset:1024 sc0 sc1
    buffer_load_dwordx4 v[56:59], v8, s[24:27], s59 offen offset:2048 sc0 sc1
    buffer_load_dwordx4 v[60:63], v8, s[24:27], s59 offen offset:3072 sc0 sc1
    s_waitcnt vmcnt(0)
    s_branch KB_tc0
KB_tr1:
    s_add_u32 s58, s58, 1
    s_cmp_lt_u32 s58, 0x20000
    s_cbranch_scc0 KB_tb1
    s_add_u32 s59, s42, 4096
    s_sleep 2
    buffer_load_dwordx4 v[64:67], v8, s[24:27], s59 offen offset:0 sc0 sc1
    buffer_load_dwordx4 v[68:71], v8, s[24:27], s59 offen offset:1024 sc0 sc1
    buffer_load_dwordx4 v[72:75], v8, s[24:27], s59 offen offset:2048 sc0 sc1
    buffer_load_dwordx4 v[76:79], v8, s[24:27], s59 offen offset:3072 sc0 sc1
    s_waitcnt vmcnt(0)
    s_branch KB_tc1
KB_tr2:
    s_add_u32 s58, s58, 1
    s_cmp_lt_u32 s58, 0x20000
    s_cbranch_scc0 KB_tb2
    s_add_u32 s59, s42, 8192
    s_sleep 2
    buffer_load_dwordx4 v[80:83], v8, s[24:27], s59 offen offset:0 sc0 sc1
    buffer_load_dwordx4 v[84:87], v8, s[24:27], s59 offen offset:1024 sc0 sc1
    buffer_load_dwordx4 v[88:91], v8, s[24:27], s59 offen offset:2048 sc0 sc1
    buffer_load_dwordx4 v[92:95], v8, s[24:27], s59 offen offset:3072 sc0 sc1
    s_waitcnt vmcnt(0)
    s_branch KB_tc2
KB_tr3:
    s_add_u32 s58, s58, 1
    s_cmp_lt_u32 s58, 0x20000
    s_cbranch_scc0 KB_tb3
    s_add_u32 s59, s42, 12288
    s_sleep 2
    buffer_load_dwordx4 v[96:99], v8, s[24:27], s59 offen offset:0 sc0 sc1
    buffer_load_dwordx4 v[100:103], v8, s[24:27], s59 offen offset:1024 sc0 sc1
    buffer_load_dwordx4 v[104:107], v8, s[24:27], s59 offen offset:2048 sc0 sc1
    buffer_load_dwordx4 v[108:111], v8, s[24:27], s59 offen offset:3072 sc0 sc1
    s_waitcnt vmcnt(0)
    s_branch KB_tc3
KB_tr4:
    s_add_u32 s58, s58, 1
    s_cmp_lt_u32 s58, 0x20000
    s_cbranch_scc0 KB_tb4
    s_add_u32 s59, s42, 16384
    s_sleep 2
    buffer_load_dwordx4 v[48:51], v8, s[24:27], s59 offen offset:0 sc0 sc1
    buffer_load_dwordx4 v[52:55], v8, s[24:27], s59 offen offset:1024 sc0 sc1
    buffer_load_dwordx4 v[56:59], v8, s[24:27], s59 offen offset:2048 sc0 sc1
    buffer_load_dwordx4 v[60:63], v8, s[24:27], s59 offen offset:3072 sc0 sc1
    s_waitcnt vmcnt(0)
    s_branch KB_tc4
KB_tr5:
    s_add_u32 s58, s58, 1
    s_cmp_lt_u32 s58, 0x20000
    s_cbranch_scc0 KB_tb5
    s_add_u32 s59, s42, 20480
    s_sleep 2
    buffer_load_dwordx4 v[64:67], v8, s[24:27], s59 offen offset:0 sc0 sc1
    buffer_load_dwordx4 v[68:71], v8, s[24:27], s59 offen offset:1024 sc0 sc1
    buffer_load_dwordx4 v[72:75], v8, s[24:27], s59 offen offset:2048 sc0 sc1
    buffer_load_dwordx4 v[76:79], v8, s[24:27], s59 offen offset:3072 sc0 sc1
    s_waitcnt vmcnt(0)
    s_branch KB_tc5
KB_tr6:
    s_add_u32 s58, s58, 1
    s_cmp_lt_u32 s58, 0x20000
    s_cbranch_scc0 KB_tb6
    s_add_u32 s59, s42, 24576
    s_sleep 2
    buffer_load_dwordx4 v[80:83], v8, s[24:27], s59 offen offset:0 sc0 sc1
    buffer_load_dwordx4 v[84:87], v8, s[24:27], s59 offen offset:1024 sc0 sc1
    buffer_load_dwordx4 v[88:91], v8, s[24:27], s59 offen offset:2048 sc0 sc1
    buffer_load_dwordx4 v[92:95], v8, s[24:27], s59 offen offset:3072 sc0 sc1
    s_waitcnt vmcnt(0)
    s_branch KB_tc6
KB_tr7:
    s_add_u32 s58, s58, 1
    s_cmp_lt_u32 s58, 0x20000
    s_cbranch_scc0 KB_tb7
    s_add_u32 s59, s42, 28672
    s_sleep 2
    buffer_load_dwordx4 v[96:99], v8, s[24:27], s59 offen offset:0 sc0 sc1
    buffer_load_dwordx4 v[100:103], v8, s[24:27], s59 offen offset:1024 sc0 sc1
    buffer_load_dwordx4 v[104:107], v8, s[24:27], s59 offen offset:2048 sc0 sc1
    buffer_load_dwordx4 v[108:111], v8, s[24:27], s59 offen offset:3072 sc0 sc1
    s_waitcnt vmcnt(0)
    s_branch KB_tc7
KB_tr8:
    s_add_u32 s58, s58, 1
    s_cmp_lt_u32 s58, 0x20000
    s_cbranch_scc0 KB_tb8
    s_add_u32 s59, s42, 32768
    s_sleep 2
    buffer_load_dwordx4 v[48:51], v8, s[24:27], s59 offen offset:0 sc0 sc1
    buffer_load_dwordx4 v[52:55], v8, s[24:27], s59 offen offset:1024 sc0 sc1
    buffer_load_dwordx4 v[56:59], v8, s[24:27], s59 offen offset:2048 sc0 sc1
    buffer_load_dwordx4 v[60:63], v8, s[24:27], s59 offen offset:3072 sc0 sc1
    s_waitcnt vmcnt(0)
    s_branch KB_tc8
KB_done:
    s_endpgm

.section .rodata,"a"
.p2align 6
.amdhsa_kernel sequential_preLN__ssm_conv_h3__glu_gated_geglu__prompt_kernel
  .amdhsa_next_free_vgpr 256
  .amdhsa_next_free_sgpr 100
  .amdhsa_accum_offset 256
  .amdhsa_group_segment_fixed_size 0
  .amdhsa_kernarg_size 104
  .amdhsa_user_sgpr_count 2
  .amdhsa_user_sgpr_kernarg_segment_ptr 1
  .amdhsa_system_sgpr_workgroup_id_x 1
  .amdhsa_float_denorm_mode_32 3
.end_amdhsa_kernel
.text
TEXT_END:
```
